```python
import torch

def _softmax(x, axis=-1):
    return torch.softmax(x, dim=axis)
def _gelu(x):
    return torch.nn.functional.gelu(x, approximate="tanh")
def _silu(x):
    return torch.nn.functional.silu(x)
def _sigmoid(x):
    return torch.sigmoid(x)
def _layernorm(x, axis=-1, eps=1e-5):
    m = x.mean(dim=axis, keepdim=True)
    v = x.var(dim=axis, keepdim=True, unbiased=False)
    return (x - m) / torch.sqrt(v + eps)
def _scatter_add(tgt, idx, src, axis=0):
    return tgt.clone().index_add_(axis, idx, src)
def _segment_sum(src, seg, n):
    out = torch.zeros((n,) + src.shape[1:], dtype=src.dtype)
    return out.index_add_(0, seg, src)
def _pad(x, pw):
    flat = tuple(v for pair in reversed(pw) for v in pair)
    return torch.nn.functional.pad(x, flat)

kernel_name = 'concat_heads__linear_attn_block__grouped_kv_mqa__prompt'

def setup_inputs():

    _w = (lambda a: (lambda t: t.to(torch.bfloat16) if t.is_floating_point() else t)(torch.as_tensor(a)))
    def _A_setup():
        B, S, D = 1, 2048, 512
        return {
            "x": _w((lambda *s: torch.randn(*s, dtype=torch.bfloat16) * 0.05)(B, S, D)),
            "wqkv": _w((lambda *s: torch.randn(*s, dtype=torch.bfloat16) * 0.8)(D, 3 * D)),
            "wo": _w((lambda *s: torch.randn(*s, dtype=torch.bfloat16) * 0.05)(D, D)),
        }
    _A_in = _A_setup()

    def _B_setup():
        B, S, D, H = 1, 2048, 512, 32
        Dh = D // H
        return {
            "x": _w((lambda *s: torch.randn(*s, dtype=torch.bfloat16) * 0.05)(B, S, D)),
            "wq": _w((lambda *s: torch.randn(*s, dtype=torch.bfloat16) * 1.6)(D, H * Dh)),
            "wk": _w((lambda *s: torch.randn(*s, dtype=torch.bfloat16) * 1.6)(D, Dh)),
            "wv": _w((lambda *s: torch.randn(*s, dtype=torch.bfloat16) * 0.05)(D, Dh)),
            "wo": _w((lambda *s: torch.randn(*s, dtype=torch.bfloat16) * 0.05)(H * Dh, D)),
        }
    _B_in = _B_setup()

    return {
        "A_x": _A_in["x"],
        "A_wqkv": _A_in["wqkv"],
        "A_wo": _A_in["wo"],
        "B_x": _B_in["x"],
        "B_wq": _B_in["wq"],
        "B_wk": _B_in["wk"],
        "B_wv": _B_in["wv"],
        "B_wo": _B_in["wo"],
    }

def reference(A_x, A_wqkv, A_wo, B_x, B_wq, B_wk, B_wv, B_wo):
    def _A_ref(x, wqkv, wo):
        B, S, D = x.shape
        H = 32; Dh = D // H
        qkv = (lambda x, *d: x.permute(*d))((x @ wqkv).reshape(B, S, 3, H, Dh), 2, 0, 3, 1, 4)
        q, k, v = qkv[0], qkv[1], qkv[2]
        phi = lambda t: torch.where(t > 0, t + 1, torch.exp(t)) + 1e-6
        pq, pk = phi(q), phi(k)
        kv = torch.einsum("bhsd,bhse->bhde", pk, v)
        z = torch.einsum("bhsd->bhd", pk)
        num = torch.einsum("bhqd,bhde->bhqe", pq, kv)
        den = torch.einsum("bhqd,bhd->bhq", pq, z)[..., None] + 1e-6
        o = num / den
        return (lambda x, *d: x.permute(*d))(o, 0, 2, 1, 3).reshape(B, S, D) @ wo

    def _B_ref(x, wq, wk, wv, wo):
        B, S, D = x.shape
        H = 32
        Dh = D // H
        q = (lambda x, *d: x.permute(*d))((x @ wq).reshape(B, S, H, Dh), 0, 2, 1, 3)
        k = x @ wk
        v = x @ wv
        scores = torch.einsum("bhqd,bkd->bhqk", q, k) * (Dh ** -0.5)
        p = _softmax(scores, axis=-1)
        o = torch.einsum("bhqk,bkd->bhqd", p, v)
        return (lambda x, *d: x.permute(*d))(o, 0, 2, 1, 3).reshape(B, S, H * Dh) @ wo

    a = _A_ref(A_x, A_wqkv, A_wo)
    b = _B_ref(B_x, B_wq, B_wk, B_wv, B_wo)
    return torch.concatenate([a, b], axis=-1)
```

```asm
; @launch grid=(256,1,1) block=(768,1,1) lds=163840
.amdgcn_target "amdgcn-amd-amdhsa--gfx950"
.text
.globl concat_heads__linear_attn_block__grouped_kv_mqa__prompt_kernel
.p2align 8
.type concat_heads__linear_attn_block__grouped_kv_mqa__prompt_kernel,@function
concat_heads__linear_attn_block__grouped_kv_mqa__prompt_kernel:
    s_cmp_ge_u32 s2, 256
    s_cbranch_scc1 KF_END
    s_load_dwordx2 s[8:9], s[0:1], 24
    s_load_dwordx2 s[12:13], s[0:1], 32
    s_load_dwordx4 s[64:67], s[0:1], 40
    s_load_dwordx2 s[4:5], s[0:1], 80
    s_load_dwordx2 s[20:21], s[0:1], 0
    s_load_dwordx2 s[24:25], s[0:1], 8
    s_load_dwordx2 s[28:29], s[0:1], 72
    s_load_dwordx2 s[68:69], s[0:1], 64
    s_load_dwordx2 s[72:73], s[0:1], 16
    s_load_dwordx2 s[76:77], s[0:1], 56
    s_mov_b32 s10, 2097152
    s_mov_b32 s11, 0x00020000
    s_mov_b32 s18, 16384
    s_mov_b32 s19, 0x00020000
    s_mov_b32 s6, 16777216
    s_mov_b32 s7, 0x00020000
    s_mov_b32 s14, 524288
    s_mov_b32 s15, 0x00020000
    s_mov_b32 s22, 2097152
    s_mov_b32 s23, 0x00020000
    s_mov_b32 s26, 1572864
    s_mov_b32 s27, 0x00020000
    s_mov_b32 s30, 256
    s_mov_b32 s31, 0x00020000
    s_mov_b32 s74, 524288
    s_mov_b32 s75, 0x00020000
    s_mov_b32 s78, 524288
    s_mov_b32 s79, 0x00020000
    s_mov_b32 s70, 4194304
    s_mov_b32 s71, 0x00020000
    v_lshrrev_b32 v1, 6, v0
    v_and_b32 v0, 63, v0
    v_readfirstlane_b32 s32, v1
    s_and_b32 s33, s2, 7
    s_lshl_b32 s33, s33, 2
    s_lshr_b32 s35, s2, 6
    s_add_u32 s33, s33, s35
    s_bfe_u32 s34, s2, 0x30003
    v_lshlrev_b32 v2, 4, v0
    v_lshrrev_b32 v148, 4, v0
    s_lshl_b32 s50, s32, 10
    s_and_b32 s51, s50, 3072
    s_cmp_ge_u32 s32, 8
    s_cbranch_scc0 KF_ATT
    s_setprio 3
    s_and_b32 s52, s32, 3
    v_lshrrev_b32 v21, 3, v0
    v_cmp_eq_u32 vcc, 2, v21
    v_lshlrev_b32 v21, 2, v0
    v_mov_b32 v13, 0
    v_cndmask_b32 v22, 0, 1, vcc
    v_add_u32 v21, 159744, v21
    ds_write_b32 v21, v22
    ds_write_b32 v21, v13 offset:256
    v_lshlrev_b32 v7, 7, v0
    s_and_b32 s35, s52, 1
    s_lshl_b32 s35, s35, 11
    s_lshr_b32 s36, s52, 1
    s_mul_i32 s38, s36, -36864
    s_lshl_b32 s36, s36, 14
    s_add_u32 s36, s36, s35
    s_add_u32 s38, s38, s35
    s_waitcnt lgkmcnt(0)
    s_cmp_ge_u32 s34, 2
    s_cbranch_scc1 KF_NOWKV
    s_cmp_lt_u32 s52, 2
    s_cselect_b32 s16, s66, s64
    s_cselect_b32 s17, s67, s65
    s_add_u32 m0, s36, 131072
    s_add_u32 s37, s35, 0
    buffer_load_dwordx4 v2, s[16:19], s37 offen offset:0 lds
    buffer_load_dwordx4 v2, s[16:19], s37 offen offset:1024 lds
    s_add_u32 m0, s36, 135168
    s_add_u32 s37, s35, 4096
    buffer_load_dwordx4 v2, s[16:19], s37 offen offset:0 lds
    buffer_load_dwordx4 v2, s[16:19], s37 offen offset:1024 lds
    s_add_u32 m0, s36, 139264
    s_add_u32 s37, s35, 8192
    buffer_load_dwordx4 v2, s[16:19], s37 offen offset:0 lds
    buffer_load_dwordx4 v2, s[16:19], s37 offen offset:1024 lds
    s_add_u32 m0, s38, 143360
    s_add_u32 s37, s35, 12288
    buffer_load_dwordx4 v2, s[16:19], s37 offen offset:0 lds
    buffer_load_dwordx4 v2, s[16:19], s37 offen offset:1024 lds
    v_mov_b64 v[24:25], 0
    v_mov_b64 v[26:27], 0
    s_lshl_b32 s35, s33, 12
    s_add_u32 s35, s35, s51
    s_add_u32 s35, s35, 8650752
    buffer_store_dwordx4 v[24:27], v2, s[4:7], s35 offen sc1
KF_NOWKV:
    s_lshl_b32 s55, s2, 2
    s_add_u32 s55, s55, s52
    s_mul_i32 s35, s55, 512
    s_mov_b64 exec, 15
    buffer_load_dword v164, v7, s[12:15], s35 offen
    s_mov_b64 exec, -1
    s_waitcnt vmcnt(2)
    s_barrier
    s_branch KF_BG2
KF_ATT:
    v_and_b32 v149, 3, v1
    v_lshl_add_u32 v149, v149, 2, v148
    v_and_b32 v150, 15, v0
    v_xor_b32 v150, v150, v149
    v_lshlrev_b32 v150, 4, v150
    v_lshl_add_u32 v137, v148, 10, v150
    s_lshl_b32 s48, s33, 16
    s_lshl_b32 s35, s32, 12
    s_add_u32 s48, s48, s35
    s_and_b32 s36, s34, 1
    s_lshl_b32 s37, s36, 15
    s_add_u32 s48, s48, s37
    s_lshl_b32 s37, s36, 13
    s_add_u32 s37, s37, s50
    s_setprio 3
    s_waitcnt lgkmcnt(0)
    s_add_u32 m0, s37, 0
    s_add_u32 s35, s48, 0
    buffer_load_dwordx4 v137, s[8:11], s35 offen nt lds
    s_add_u32 m0, s37, 16384
    s_add_u32 s35, s48, 256
    buffer_load_dwordx4 v137, s[8:11], s35 offen nt lds
    s_add_u32 m0, s37, 32768
    s_add_u32 s35, s48, 512
    buffer_load_dwordx4 v137, s[8:11], s35 offen nt lds
    s_add_u32 m0, s37, 49152
    s_add_u32 s35, s48, 768
    buffer_load_dwordx4 v137, s[8:11], s35 offen nt lds
    v_and_b32 v149, 1, v148
    v_lshlrev_b32 v149, 2, v149
    v_and_b32 v151, 7, v0
    v_xor_b32 v150, v151, v149
    v_lshlrev_b32 v150, 4, v150
    v_lshrrev_b32 v149, 3, v0
    v_lshl_add_u32 v138, v149, 10, v150
    s_lshl_b32 s49, s32, 13
    s_lshl_b32 s35, s34, 7
    s_add_u32 s49, s49, s35
    s_bfe_u32 s38, s32, 0x10001
    v_and_b32 v153, 3, v0
    v_lshrrev_b32 v154, 5, v0
    v_bfe_u32 v155, v0, 2, 2
    v_lshl_add_u32 v156, v154, 3, v155
    v_and_b32 v157, 1, v148
    v_and_b32 v158, 31, v0
    s_bfe_u32 s35, s32, 0x10002
    s_lshl_b32 s35, s35, 13
    s_lshl_b32 s36, s38, 7
    s_add_u32 s35, s35, s36
    v_and_b32 v150, 15, v0
    v_xor_b32 v150, v150, v154
    v_lshlrev_b32 v152, 8, v158
    v_lshl_add_u32 v152, v150, 4, v152
    v_xor_b32 v128, s35, v152
    v_xor_b32 v129, 32, v128
    v_xor_b32 v130, 64, v128
    v_xor_b32 v131, 96, v128
    s_lshl_b32 s35, s32, 12
    v_add_u32 v42, s35, v2
    v_xor_b32 v43, 8192, v42
    s_lshl_b32 s35, s32, 2
    s_add_u32 s35, s35, 159744
    v_mov_b32 v40, s35
    v_mov_b32 v41, 1
    v_lshlrev_b32 v133, 2, v151
    v_add_u32 v133, 159744, v133
    s_mov_b32 s37, 0
    s_lshr_b32 s35, s32, 2
    s_cmp_eq_u32 s35, s34
    s_cbranch_scc1 KF_G3
    s_and_b32 s36, s34, 1
    s_cmp_eq_u32 s35, s36
    s_cbranch_scc1 KF_PLAIN
    s_and_b32 s61, s49, 0x7fff
    s_lshl_b32 s36, s35, 13
    s_add_u32 s36, s36, s51
    s_lshl_b32 s48, s36, 2
    s_lshl_b32 s39, s33, 16
    s_add_u32 s48, s48, s39
    s_waitcnt vmcnt(0)
    s_barrier
    s_add_u32 m0, s36, 0
    s_add_u32 s35, s48, 0
    buffer_load_dwordx4 v137, s[8:11], s35 offen nt lds
    s_add_u32 m0, s36, 4096
    s_add_u32 s35, s48, 16384
    buffer_load_dwordx4 v137, s[8:11], s35 offen nt lds
    s_add_u32 m0, s36, 16384
    s_add_u32 s35, s48, 256
    buffer_load_dwordx4 v137, s[8:11], s35 offen nt lds
    s_add_u32 m0, s36, 20480
    s_add_u32 s35, s48, 16640
    buffer_load_dwordx4 v137, s[8:11], s35 offen nt lds
    s_add_u32 m0, s36, 32768
    s_add_u32 s35, s48, 512
    buffer_load_dwordx4 v137, s[8:11], s35 offen nt lds
    s_add_u32 m0, s36, 36864
    s_add_u32 s35, s48, 16896
    buffer_load_dwordx4 v137, s[8:11], s35 offen nt lds
    s_add_u32 m0, s36, 49152
    s_add_u32 s35, s48, 768
    buffer_load_dwordx4 v137, s[8:11], s35 offen nt lds
    s_add_u32 m0, s36, 53248
    s_add_u32 s35, s48, 17152
    buffer_load_dwordx4 v137, s[8:11], s35 offen nt lds
    ds_write_b32 v40, v41 offset:224
    ds_write_b32 v40, v41 offset:384
    s_add_u32 m0, s51, 65536
    s_add_u32 s35, s61, 229376
    buffer_load_dwordx4 v138, s[12:15], s35 offen lds
    s_add_u32 m0, s51, 69632
    s_add_u32 s35, s61, 262144
    buffer_load_dwordx4 v138, s[12:15], s35 offen lds
    s_add_u32 m0, s51, 73728
    s_add_u32 s35, s61, 294912
    buffer_load_dwordx4 v138, s[12:15], s35 offen lds
    s_add_u32 m0, s51, 77824
    s_add_u32 s35, s61, 327680
    buffer_load_dwordx4 v138, s[12:15], s35 offen lds
    s_add_u32 m0, s51, 81920
    s_add_u32 s35, s61, 360448
    buffer_load_dwordx4 v138, s[12:15], s35 offen lds
    s_add_u32 m0, s51, 86016
    s_add_u32 s35, s61, 393216
    buffer_load_dwordx4 v138, s[12:15], s35 offen lds
    s_add_u32 m0, s51, 90112
    s_add_u32 s35, s61, 425984
    buffer_load_dwordx4 v138, s[12:15], s35 offen lds
    s_add_u32 m0, s51, 94208
    s_add_u32 s35, s61, 458752
    buffer_load_dwordx4 v138, s[12:15], s35 offen lds
    s_add_u32 m0, s51, 98304
    s_add_u32 s35, s61, 491520
    buffer_load_dwordx4 v138, s[12:15], s35 offen lds
    s_waitcnt vmcnt(9)
    ds_write_b32 v40, v41 offset:448
KF_X2W:
    ds_read_b32 v134, v133 offset:448
    s_waitcnt lgkmcnt(0)
    v_cmp_ne_u32 vcc, 1, v134
    s_cbranch_vccnz KF_X2W
    ds_read_b128 v[64:67], v128 offset:0
    ds_read_b128 v[68:71], v129 offset:0
    ds_read_b128 v[72:75], v130 offset:0
    ds_read_b128 v[76:79], v131 offset:0
    ds_read_b128 v[80:83], v128 offset:16384
    ds_read_b128 v[84:87], v129 offset:16384
    ds_read_b128 v[88:91], v130 offset:16384
    ds_read_b128 v[92:95], v131 offset:16384
    ds_read_b128 v[96:99], v128 offset:32768
    ds_read_b128 v[100:103], v129 offset:32768
    ds_read_b128 v[104:107], v130 offset:32768
    ds_read_b128 v[108:111], v131 offset:32768
    ds_read_b128 v[112:115], v128 offset:49152
    ds_read_b128 v[116:119], v129 offset:49152
    ds_read_b128 v[120:123], v130 offset:49152
    ds_read_b128 v[124:127], v131 offset:49152
    s_waitcnt lgkmcnt(0)
    ds_write_b32 v40, v41 offset:480
KF_XCW:
    ds_read_b32 v134, v133 offset:480
    s_waitcnt lgkmcnt(0)
    v_cmp_ne_u32 vcc, 1, v134
    s_cbranch_vccnz KF_XCW
    s_add_u32 m0, s51, 36864
    s_add_u32 s35, s61, 0
    buffer_load_dwordx4 v138, s[12:15], s35 offen lds
    s_add_u32 m0, s51, 40960
    s_add_u32 s35, s61, 32768
    buffer_load_dwordx4 v138, s[12:15], s35 offen lds
    s_add_u32 m0, s51, 45056
    s_add_u32 s35, s61, 65536
    buffer_load_dwordx4 v138, s[12:15], s35 offen lds
    s_add_u32 m0, s51, 49152
    s_add_u32 s35, s61, 98304
    buffer_load_dwordx4 v138, s[12:15], s35 offen lds
    s_add_u32 m0, s51, 53248
    s_add_u32 s35, s61, 131072
    buffer_load_dwordx4 v138, s[12:15], s35 offen lds
    s_add_u32 m0, s51, 57344
    s_add_u32 s35, s61, 163840
    buffer_load_dwordx4 v138, s[12:15], s35 offen lds
    s_add_u32 m0, s51, 61440
    s_add_u32 s35, s61, 196608
    buffer_load_dwordx4 v138, s[12:15], s35 offen lds
    s_branch KF_NOGO
KF_PLAIN:
    s_waitcnt vmcnt(0)
    s_barrier
    ds_write_b32 v40, v41 offset:448
    ds_read_b128 v[64:67], v128 offset:0
    ds_read_b128 v[68:71], v129 offset:0
    ds_read_b128 v[72:75], v130 offset:0
    ds_read_b128 v[76:79], v131 offset:0
    ds_read_b128 v[80:83], v128 offset:16384
    ds_read_b128 v[84:87], v129 offset:16384
    ds_read_b128 v[88:91], v130 offset:16384
    ds_read_b128 v[92:95], v131 offset:16384
    ds_read_b128 v[96:99], v128 offset:32768
    ds_read_b128 v[100:103], v129 offset:32768
    ds_read_b128 v[104:107], v130 offset:32768
    ds_read_b128 v[108:111], v131 offset:32768
    ds_read_b128 v[112:115], v128 offset:49152
    ds_read_b128 v[116:119], v129 offset:49152
    ds_read_b128 v[120:123], v130 offset:49152
    ds_read_b128 v[124:127], v131 offset:49152
    ds_write_b32 v40, v41 offset:224
    ds_write_b32 v40, v41 offset:384
    ds_write_b32 v40, v41 offset:480
    s_branch KF_NOGO
KF_G3:
    v_lshlrev_b32 v150, 14, v157
    v_lshl_add_u32 v150, v156, 5, v150
    v_lshl_add_u32 v150, v153, 3, v150
    s_lshl_b32 s35, s38, 11
    s_add_u32 s35, s35, 0x20000
    v_add_u32 v135, s35, v150
    v_mul_u32_u24 v150, 53248, v157
    v_sub_u32 v139, v135, v150
    v_xor_b32 v46, 8, v40
    s_lshl_b32 s35, s50, 1
    v_add_u32 v22, s35, v2
    v_xor_b32 v23, 4096, v22
    s_lshl_b32 s35, s34, 4
    s_add_u32 s35, s35, 159744
    v_lshl_add_u32 v47, v153, 2, s35
    s_lshl_b32 s35, s33, 1
    s_bfe_u32 s36, s32, 0x10002
    s_add_u32 s35, s35, s36
    s_mul_i32 s41, s35, 2112
    v_mov_b32 v45, 2147483632
    s_bitcmp1_b32 s32, 0
    s_cbranch_scc1 KF_G3V
    v_and_b32 v44, 0x13, v158
    v_bfe_u32 v20, v158, 2, 1
    v_lshl_or_b32 v44, v20, 3, v44
    v_bfe_u32 v20, v158, 3, 1
    v_lshl_or_b32 v44, v20, 2, v44
    v_lshl_add_u32 v44, v154, 5, v44
    v_lshlrev_b32 v44, 4, v44
    s_cmp_eq_u32 s38, 0
    s_cselect_b64 vcc, -1, 0
    v_cndmask_b32 v44, v45, v44, vcc
    s_mov_b32 s46, 0x3eb8aa3b
    s_mov_b32 s47, 0x3eb8aa3b
    s_waitcnt vmcnt(0)
    s_barrier
    ds_write_b32 v40, v41 offset:448
    ds_read_b128 v[64:67], v128 offset:0
    ds_read_b128 v[68:71], v129 offset:0
    ds_read_b128 v[72:75], v130 offset:0
    ds_read_b128 v[76:79], v131 offset:0
    ds_read_b128 v[80:83], v128 offset:16384
    ds_read_b128 v[84:87], v129 offset:16384
    ds_read_b128 v[88:91], v130 offset:16384
    ds_read_b128 v[92:95], v131 offset:16384
    ds_read_b128 v[96:99], v128 offset:32768
    ds_read_b128 v[100:103], v129 offset:32768
    ds_read_b128 v[104:107], v130 offset:32768
    ds_read_b128 v[108:111], v131 offset:32768
    ds_read_b128 v[112:115], v128 offset:49152
    ds_read_b128 v[116:119], v129 offset:49152
    ds_read_b128 v[120:123], v130 offset:49152
    ds_read_b128 v[124:127], v131 offset:49152
    ds_read_b64_tr_b16 v[24:25], v135 offset:0
    ds_read_b64_tr_b16 v[26:27], v135 offset:128
    ds_read_b64_tr_b16 v[28:29], v135 offset:512
    ds_read_b64_tr_b16 v[30:31], v135 offset:640
    ds_read_b64_tr_b16 v[32:33], v135 offset:1024
    ds_read_b64_tr_b16 v[34:35], v135 offset:1152
    ds_read_b64_tr_b16 v[36:37], v135 offset:1536
    ds_read_b64_tr_b16 v[38:39], v135 offset:1664
    ds_read_b64_tr_b16 v[4:5], v135 offset:4096
    ds_read_b64_tr_b16 v[6:7], v135 offset:4224
    ds_read_b64_tr_b16 v[8:9], v135 offset:4608
    ds_read_b64_tr_b16 v[10:11], v135 offset:4736
    ds_read_b64_tr_b16 v[12:13], v135 offset:5120
    ds_read_b64_tr_b16 v[14:15], v135 offset:5248
    ds_read_b64_tr_b16 v[16:17], v135 offset:5632
    ds_read_b64_tr_b16 v[18:19], v135 offset:5760
    s_waitcnt lgkmcnt(8)
    ds_write_b32 v40, v41 offset:480
    v_mfma_f32_32x32x16_bf16 v[48:63], v[24:27], v[64:67], 0
    v_mfma_f32_32x32x16_bf16 v[48:63], v[28:31], v[68:71], v[48:63]
    v_mfma_f32_32x32x16_bf16 v[48:63], v[32:35], v[72:75], v[48:63]
    v_mfma_f32_32x32x16_bf16 v[48:63], v[36:39], v[76:79], v[48:63]
    ds_read_b64_tr_b16 v[24:25], v135 offset:8192
    ds_read_b64_tr_b16 v[26:27], v135 offset:8320
    ds_read_b64_tr_b16 v[28:29], v135 offset:8704
    ds_read_b64_tr_b16 v[30:31], v135 offset:8832
    ds_read_b64_tr_b16 v[32:33], v135 offset:9216
    ds_read_b64_tr_b16 v[34:35], v135 offset:9344
    ds_read_b64_tr_b16 v[36:37], v135 offset:9728
    ds_read_b64_tr_b16 v[38:39], v135 offset:9856
    s_waitcnt lgkmcnt(8)
    v_mfma_f32_32x32x16_bf16 v[48:63], v[4:7], v[80:83], v[48:63]
    v_mfma_f32_32x32x16_bf16 v[48:63], v[8:11], v[84:87], v[48:63]
    v_mfma_f32_32x32x16_bf16 v[48:63], v[12:15], v[88:91], v[48:63]
    v_mfma_f32_32x32x16_bf16 v[48:63], v[16:19], v[92:95], v[48:63]
    ds_read_b64_tr_b16 v[4:5], v139 offset:12288
    ds_read_b64_tr_b16 v[6:7], v139 offset:12416
    ds_read_b64_tr_b16 v[8:9], v139 offset:12800
    ds_read_b64_tr_b16 v[10:11], v139 offset:12928
    ds_read_b64_tr_b16 v[12:13], v139 offset:13312
    ds_read_b64_tr_b16 v[14:15], v139 offset:13440
    ds_read_b64_tr_b16 v[16:17], v139 offset:13824
    ds_read_b64_tr_b16 v[18:19], v139 offset:13952
    s_waitcnt lgkmcnt(8)
    v_mfma_f32_32x32x16_bf16 v[48:63], v[24:27], v[96:99], v[48:63]
    v_mfma_f32_32x32x16_bf16 v[48:63], v[28:31], v[100:103], v[48:63]
    v_mfma_f32_32x32x16_bf16 v[48:63], v[32:35], v[104:107], v[48:63]
    v_mfma_f32_32x32x16_bf16 v[48:63], v[36:39], v[108:111], v[48:63]
    s_waitcnt lgkmcnt(0)
    ds_write_b32 v40, v41 offset:384
    v_mfma_f32_32x32x16_bf16 v[48:63], v[4:7], v[112:115], v[48:63]
    v_mfma_f32_32x32x16_bf16 v[48:63], v[8:11], v[116:119], v[48:63]
    v_mfma_f32_32x32x16_bf16 v[48:63], v[12:15], v[120:123], v[48:63]
    v_mfma_f32_32x32x16_bf16 v[48:63], v[16:19], v[124:127], v[48:63]
KF_GW1:
    ds_read_b32 v134, v47 offset:480
    s_waitcnt lgkmcnt(0)
    v_cmp_ne_u32 vcc, 1, v134
    s_cbranch_vccnz KF_GW1
    s_nop 7
    ds_write_b128 v22, v[56:59] offset:0
    ds_write_b128 v22, v[60:63] offset:1024
    s_waitcnt lgkmcnt(0)
    ds_write_b32 v40, v41 offset:416
KF_PS0:
    ds_read_b32 v134, v46 offset:416
    s_waitcnt lgkmcnt(0)
    v_cmp_ne_u32 vcc, 1, v134
    s_cbranch_vccnz KF_PS0
    ds_read_b128 v[24:27], v23 offset:0
    ds_read_b128 v[28:31], v23 offset:1024
    s_waitcnt lgkmcnt(0)
    v_pk_add_f32 v[24:25], v[24:25], v[56:57]
    v_pk_add_f32 v[26:27], v[26:27], v[58:59]
    v_pk_add_f32 v[28:29], v[28:29], v[60:61]
    v_pk_add_f32 v[30:31], v[30:31], v[62:63]
    v_pk_mul_f32 v[24:25], v[24:25], s[46:47]
    v_pk_mul_f32 v[26:27], v[26:27], s[46:47]
    v_pk_mul_f32 v[28:29], v[28:29], s[46:47]
    v_pk_mul_f32 v[30:31], v[30:31], s[46:47]
    v_cvt_pk_bf16_f32 v20, v24, v25
    v_cvt_pk_bf16_f32 v21, v26, v27
    v_cvt_pk_bf16_f32 v22, v28, v29
    v_cvt_pk_bf16_f32 v23, v30, v31
    buffer_store_dwordx4 v[20:23], v44, s[4:7], s41 offen sc1
    s_branch KF_B0D
KF_G3V:
    v_lshl_add_u32 v44, v154, 4, v158
    v_lshlrev_b32 v44, 4, v44
    v_cmp_gt_u32 s[64:65], 16, v158
    s_nop 1
    v_cndmask_b32 v44, v45, v44, s[64:65]
    v_mov_b32 v20, 512
    v_cmp_eq_u32 s[62:63], 16, v0
    s_nop 1
    v_cndmask_b32 v44, v44, v20, s[62:63]
    v_mov_b32 v45, 0x3f803f80
    v_cndmask_b32 v45, 0, v45, s[62:63]
    v_mov_b32 v20, 528
    v_cmp_eq_u32 s[62:63], 17, v0
    s_nop 1
    v_cndmask_b32 v44, v44, v20, s[62:63]
    s_mul_i32 s35, s38, 544
    s_add_u32 s41, s41, s35
    s_waitcnt vmcnt(0)
    s_barrier
    ds_write_b32 v40, v41 offset:448
    ds_read_b128 v[64:67], v128 offset:0
    ds_read_b128 v[68:71], v129 offset:0
    ds_read_b128 v[72:75], v130 offset:0
    ds_read_b128 v[76:79], v131 offset:0
    ds_read_b128 v[80:83], v128 offset:16384
    ds_read_b128 v[84:87], v129 offset:16384
    ds_read_b128 v[88:91], v130 offset:16384
    ds_read_b128 v[92:95], v131 offset:16384
    ds_read_b128 v[96:99], v128 offset:32768
    ds_read_b128 v[100:103], v129 offset:32768
    ds_read_b128 v[104:107], v130 offset:32768
    ds_read_b128 v[108:111], v131 offset:32768
    ds_read_b128 v[112:115], v128 offset:49152
    ds_read_b128 v[116:119], v129 offset:49152
    ds_read_b128 v[120:123], v130 offset:49152
    ds_read_b128 v[124:127], v131 offset:49152
    ds_read_b64_tr_b16 v[24:25], v135 offset:0
    ds_read_b64_tr_b16 v[26:27], v135 offset:128
    ds_read_b64_tr_b16 v[28:29], v135 offset:512
    ds_read_b64_tr_b16 v[30:31], v135 offset:640
    ds_read_b64_tr_b16 v[32:33], v135 offset:1024
    ds_read_b64_tr_b16 v[34:35], v135 offset:1152
    ds_read_b64_tr_b16 v[36:37], v135 offset:1536
    ds_read_b64_tr_b16 v[38:39], v135 offset:1664
    ds_read_b64_tr_b16 v[4:5], v135 offset:4096
    ds_read_b64_tr_b16 v[6:7], v135 offset:4224
    ds_read_b64_tr_b16 v[8:9], v135 offset:4608
    ds_read_b64_tr_b16 v[10:11], v135 offset:4736
    ds_read_b64_tr_b16 v[12:13], v135 offset:5120
    ds_read_b64_tr_b16 v[14:15], v135 offset:5248
    ds_read_b64_tr_b16 v[16:17], v135 offset:5632
    ds_read_b64_tr_b16 v[18:19], v135 offset:5760
    s_waitcnt lgkmcnt(8)
    ds_write_b32 v40, v41 offset:480
    v_mfma_f32_32x32x16_bf16 v[48:63], v[64:67], v[24:27], 0
    v_mfma_f32_32x32x16_bf16 v[48:63], v[68:71], v[28:31], v[48:63]
    v_mfma_f32_32x32x16_bf16 v[48:63], v[72:75], v[32:35], v[48:63]
    v_mfma_f32_32x32x16_bf16 v[48:63], v[76:79], v[36:39], v[48:63]
    ds_read_b64_tr_b16 v[24:25], v135 offset:8192
    ds_read_b64_tr_b16 v[26:27], v135 offset:8320
    ds_read_b64_tr_b16 v[28:29], v135 offset:8704
    ds_read_b64_tr_b16 v[30:31], v135 offset:8832
    ds_read_b64_tr_b16 v[32:33], v135 offset:9216
    ds_read_b64_tr_b16 v[34:35], v135 offset:9344
    ds_read_b64_tr_b16 v[36:37], v135 offset:9728
    ds_read_b64_tr_b16 v[38:39], v135 offset:9856
    s_waitcnt lgkmcnt(8)
    v_mfma_f32_32x32x16_bf16 v[48:63], v[80:83], v[4:7], v[48:63]
    v_mfma_f32_32x32x16_bf16 v[48:63], v[84:87], v[8:11], v[48:63]
    v_mfma_f32_32x32x16_bf16 v[48:63], v[88:91], v[12:15], v[48:63]
    v_mfma_f32_32x32x16_bf16 v[48:63], v[92:95], v[16:19], v[48:63]
    ds_read_b64_tr_b16 v[4:5], v139 offset:12288
    ds_read_b64_tr_b16 v[6:7], v139 offset:12416
    ds_read_b64_tr_b16 v[8:9], v139 offset:12800
    ds_read_b64_tr_b16 v[10:11], v139 offset:12928
    ds_read_b64_tr_b16 v[12:13], v139 offset:13312
    ds_read_b64_tr_b16 v[14:15], v139 offset:13440
    ds_read_b64_tr_b16 v[16:17], v139 offset:13824
    ds_read_b64_tr_b16 v[18:19], v139 offset:13952
    s_waitcnt lgkmcnt(8)
    v_mfma_f32_32x32x16_bf16 v[48:63], v[96:99], v[24:27], v[48:63]
    v_mfma_f32_32x32x16_bf16 v[48:63], v[100:103], v[28:31], v[48:63]
    v_mfma_f32_32x32x16_bf16 v[48:63], v[104:107], v[32:35], v[48:63]
    v_mfma_f32_32x32x16_bf16 v[48:63], v[108:111], v[36:39], v[48:63]
    s_waitcnt lgkmcnt(0)
    ds_write_b32 v40, v41 offset:384
    v_mfma_f32_32x32x16_bf16 v[48:63], v[112:115], v[4:7], v[48:63]
    v_mfma_f32_32x32x16_bf16 v[48:63], v[116:119], v[8:11], v[48:63]
    v_mfma_f32_32x32x16_bf16 v[48:63], v[120:123], v[12:15], v[48:63]
    v_mfma_f32_32x32x16_bf16 v[48:63], v[124:127], v[16:19], v[48:63]
KF_GW2:
    ds_read_b32 v134, v47 offset:480
    s_waitcnt lgkmcnt(0)
    v_cmp_ne_u32 vcc, 1, v134
    s_cbranch_vccnz KF_GW2
    s_cmp_lg_u32 s38, 0
    s_nop 5
    s_cbranch_scc1 KF_G3V1
    s_nop 5
    ds_write_b128 v22, v[56:59] offset:0
    ds_write_b128 v22, v[60:63] offset:1024
    s_waitcnt lgkmcnt(0)
    ds_write_b32 v40, v41 offset:416
KF_PS1:
    ds_read_b32 v134, v46 offset:416
    s_waitcnt lgkmcnt(0)
    v_cmp_ne_u32 vcc, 1, v134
    s_cbranch_vccnz KF_PS1
    ds_read_b128 v[24:27], v23 offset:0
    ds_read_b128 v[28:31], v23 offset:1024
    s_waitcnt lgkmcnt(0)
    v_pk_add_f32 v[24:25], v[24:25], v[48:49]
    v_pk_add_f32 v[26:27], v[26:27], v[50:51]
    v_pk_add_f32 v[28:29], v[28:29], v[52:53]
    v_pk_add_f32 v[30:31], v[30:31], v[54:55]
    s_branch KF_G3V2
KF_G3V1:
    ds_write_b128 v22, v[48:51] offset:0
    ds_write_b128 v22, v[52:55] offset:1024
    s_waitcnt lgkmcnt(0)
    ds_write_b32 v40, v41 offset:416
KF_PS9:
    ds_read_b32 v134, v46 offset:416
    s_waitcnt lgkmcnt(0)
    v_cmp_ne_u32 vcc, 1, v134
    s_cbranch_vccnz KF_PS9
    ds_read_b128 v[24:27], v23 offset:0
    ds_read_b128 v[28:31], v23 offset:1024
    s_waitcnt lgkmcnt(0)
    v_pk_add_f32 v[24:25], v[24:25], v[56:57]
    v_pk_add_f32 v[26:27], v[26:27], v[58:59]
    v_pk_add_f32 v[28:29], v[28:29], v[60:61]
    v_pk_add_f32 v[30:31], v[30:31], v[62:63]
KF_G3V2:
    v_cvt_pk_bf16_f32 v20, v24, v25
    v_cvt_pk_bf16_f32 v21, v26, v27
    v_cvt_pk_bf16_f32 v22, v28, v29
    v_cvt_pk_bf16_f32 v23, v30, v31
    v_cndmask_b32 v20, v45, v20, s[64:65]
    v_cndmask_b32 v21, v45, v21, s[64:65]
    v_cndmask_b32 v22, v45, v22, s[64:65]
    v_cndmask_b32 v23, v45, v23, s[64:65]
    buffer_store_dwordx4 v[20:23], v44, s[4:7], s41 offen offset:1024 sc1
KF_B0D:
    ds_write_b32 v40, v41 offset:288
    s_cmp_eq_u32 s51, 2048
    s_cselect_b32 s37, 1, 0
KF_NOGO:
    v_mov_b32 v132, 2147483632
    v_cmp_eq_u32 vcc, 0, v0
    s_nop 1
    v_cndmask_b32 v132, v132, v0, vcc
    s_and_b32 s36, s32, 1
    v_lshrrev_b32 v150, 1, v155
    v_xor_b32 v150, s36, v150
    v_lshlrev_b32 v150, 6, v150
    v_lshl_add_u32 v150, v157, 5, v150
    v_lshl_add_u32 v161, v153, 3, v150
    v_lshl_add_u32 v150, v156, 7, v161
    s_lshl_b32 s35, s38, 13
    s_add_u32 s35, s35, 36864
    v_add_u32 v136, s35, v150
    s_mul_i32 s41, s38, 16896
    v_add_u32 v21, s41, v2
    v_lshl_add_u32 v44, v154, 4, v158
    v_lshlrev_b32 v44, 4, v44
    v_mov_b32 v45, 528
    v_cmp_gt_u32 vcc, 16, v158
    v_and_b32 v23, 27, v158
    s_nop 0
    v_cndmask_b32 v44, v45, v44, vcc
    v_cmp_eq_u32 vcc, 16, v23
    v_mov_b32 v45, 512
    s_add_u32 s35, s41, 1024
    v_cndmask_b32 v44, v44, v45, vcc
    v_add_u32 v20, s35, v44
    v_lshl_add_u32 v150, v154, 2, v155
    v_lshl_add_u32 v150, v150, 7, v161
    s_lshl_b32 s35, s38, 15
    v_add_u32 v147, s35, v150
    s_bfe_u32 s36, s32, 0x10002
    s_lshl_b32 s36, s36, 15
    s_lshl_b32 s35, s38, 14
    s_add_u32 s35, s35, s36
    s_add_u32 s35, s35, 65536
    v_add_u32 v162, s35, v2
    v_lshlrev_b32 v163, 11, v158
    v_lshl_add_u32 v163, v154, 4, v163
    s_lshl_b32 s60, s33, 10
    s_add_u32 s60, s60, 8732672
    s_lshl_b32 s35, s34, 2
    v_lshl_add_u32 v164, v151, 7, s35
    s_lshl_b32 s35, s34, 7
    v_cmp_eq_u32 vcc, s34, v151
    v_xor_b32 v165, 1, v151
    s_nop 0
    v_cndmask_b32 v165, v151, v165, vcc
    v_lshl_add_u32 v165, v165, 2, s35
    s_lshl_b32 s53, s33, 16
    s_add_u32 s53, s53, s50
    s_add_u32 s53, s53, 6553600
    s_lshl_b32 s40, s33, 16
    s_bfe_u32 s39, s32, 0x10002
    s_lshl_b32 s39, s39, 15
    s_add_u32 s40, s40, s39
    s_lshl_b32 s58, s40, 1
    s_lshl_b32 s39, s34, 12
    s_add_u32 s40, s40, s39
    s_and_b32 s39, s32, 1
    s_lshl_b32 s39, s39, 11
    s_add_u32 s40, s40, s39
    s_lshl_b32 s39, s38, 10
    s_add_u32 s40, s40, s39
    s_and_b32 s39, s40, 0x7fff
    s_lshr_b32 s39, s39, 5
    s_add_u32 s58, s58, s39
    s_add_u32 s58, s58, 1024
    s_add_u32 s40, s40, 6553600
    s_and_b32 s35, s32, 1
    s_lshl_b32 s35, s35, 3
    v_or_b32 v150, s35, v154
    v_and_b32 v152, 15, v0
    v_xor_b32 v150, v150, v152
    v_lshlrev_b32 v152, 8, v158
    v_lshl_add_u32 v150, v150, 4, v152
    s_lshr_b32 s35, s32, 2
    s_lshl_b32 s35, s35, 13
    s_lshl_b32 s36, s38, 14
    s_add_u32 s35, s35, s36
    s_add_u32 s35, s35, 131072
    v_add_u32 v140, s35, v150
    v_xor_b32 v141, 32, v140
    v_xor_b32 v142, 64, v140
    v_xor_b32 v143, 96, v140
    s_lshl_b32 s35, s32, 3
    v_add_u32 v150, s35, v149
    v_and_b32 v152, 15, v150
    v_lshlrev_b32 v144, 1, v151
    v_xor_b32 v144, v144, v152
    v_lshlrev_b32 v144, 4, v144
    v_lshl_add_u32 v144, v150, 8, v144
    v_add_u32 v144, 0x20000, v144
    v_xor_b32 v145, 16, v144
    v_lshlrev_b32 v146, 11, v150
    v_lshl_add_u32 v146, v151, 4, v146
    s_lshl_b32 s58, s33, 17
    s_lshl_b32 s35, s34, 7
    s_add_u32 s58, s58, s35
    s_add_u32 s58, s58, 1024
    s_mul_i32 s39, s32, 3072
    s_add_u32 s39, s39, 135168
    v_add_u32 v159, s39, v2
    s_xor_b32 s39, s32, 2
    s_mul_i32 s39, s39, 3072
    s_add_u32 s39, s39, 135168
    v_add_u32 v160, s39, v2
    s_waitcnt vmcnt(0)
    ds_write_b32 v40, v41 offset:224
    ds_write_b32 v40, v41 offset:288
    s_cmp_lg_u32 s37, 1
    s_cbranch_scc1 KF_WL
    v_mov_b32 v47, 1
KF_SGZ:
    ds_read_b32 v134, v133 offset:192
    s_waitcnt lgkmcnt(0)
    v_cmp_ne_u32 vcc, 1, v134
    s_cbranch_vccnz KF_SGZ
KF_SGW:
    ds_read_b32 v134, v133 offset:224
    s_waitcnt lgkmcnt(0)
    v_cmp_ne_u32 vcc, 1, v134
    s_cbranch_vccnz KF_SGW
    buffer_atomic_add v47, v132, s[28:31], 0 offen sc0
    s_waitcnt vmcnt(0)
    v_readfirstlane_b32 s62, v47
    s_nop 0
    s_cmp_lg_u32 s62, 63
    s_cbranch_scc1 KF_WL
    buffer_store_dword v41, v132, s[28:31], 0 offen offset:128 sc1
KF_WL:
KF_WLW:
    ds_read_b32 v134, v133 offset:288
    s_waitcnt lgkmcnt(0)
    v_cmp_ne_u32 vcc, 1, v134
    s_cbranch_vccnz KF_WLW
    v_mov_b32 v46, 128
    ds_read_b64_tr_b16 v[24:25], v136 offset:0
    ds_read_b64_tr_b16 v[26:27], v136 offset:512
    ds_read_b64_tr_b16 v[28:29], v136 offset:2048
    ds_read_b64_tr_b16 v[30:31], v136 offset:2560
    ds_read_b64_tr_b16 v[32:33], v136 offset:4096
    ds_read_b64_tr_b16 v[34:35], v136 offset:4608
    ds_read_b64_tr_b16 v[36:37], v136 offset:6144
    ds_read_b64_tr_b16 v[38:39], v136 offset:6656
    ds_read_b64_tr_b16 v[4:5], v136 offset:16384
    ds_read_b64_tr_b16 v[6:7], v136 offset:16896
    ds_read_b64_tr_b16 v[8:9], v136 offset:18432
    ds_read_b64_tr_b16 v[10:11], v136 offset:18944
    ds_read_b64_tr_b16 v[12:13], v136 offset:20480
    ds_read_b64_tr_b16 v[14:15], v136 offset:20992
    ds_read_b64_tr_b16 v[16:17], v136 offset:22528
    ds_read_b64_tr_b16 v[18:19], v136 offset:23040
    s_waitcnt lgkmcnt(8)
    v_mfma_f32_32x32x16_bf16 v[48:63], v[24:27], v[64:67], 0
    v_mfma_f32_32x32x16_bf16 v[48:63], v[28:31], v[68:71], v[48:63]
    v_mfma_f32_32x32x16_bf16 v[48:63], v[32:35], v[72:75], v[48:63]
    v_mfma_f32_32x32x16_bf16 v[48:63], v[36:39], v[76:79], v[48:63]
    ds_read_b64_tr_b16 v[24:25], v136 offset:32768
    ds_read_b64_tr_b16 v[26:27], v136 offset:33280
    ds_read_b64_tr_b16 v[28:29], v136 offset:34816
    ds_read_b64_tr_b16 v[30:31], v136 offset:35328
    ds_read_b64_tr_b16 v[32:33], v136 offset:36864
    ds_read_b64_tr_b16 v[34:35], v136 offset:37376
    ds_read_b64_tr_b16 v[36:37], v136 offset:38912
    ds_read_b64_tr_b16 v[38:39], v136 offset:39424
    s_waitcnt lgkmcnt(8)
    v_mfma_f32_32x32x16_bf16 v[48:63], v[4:7], v[80:83], v[48:63]
    v_mfma_f32_32x32x16_bf16 v[48:63], v[8:11], v[84:87], v[48:63]
    v_mfma_f32_32x32x16_bf16 v[48:63], v[12:15], v[88:91], v[48:63]
    v_mfma_f32_32x32x16_bf16 v[48:63], v[16:19], v[92:95], v[48:63]
    ds_read_b64_tr_b16 v[4:5], v136 offset:49152
    ds_read_b64_tr_b16 v[6:7], v136 offset:49664
    ds_read_b64_tr_b16 v[8:9], v136 offset:51200
    ds_read_b64_tr_b16 v[10:11], v136 offset:51712
    ds_read_b64_tr_b16 v[12:13], v136 offset:53248
    ds_read_b64_tr_b16 v[14:15], v136 offset:53760
    ds_read_b64_tr_b16 v[16:17], v136 offset:55296
    ds_read_b64_tr_b16 v[18:19], v136 offset:55808
    s_waitcnt lgkmcnt(8)
    v_mfma_f32_32x32x16_bf16 v[48:63], v[24:27], v[96:99], v[48:63]
    v_mfma_f32_32x32x16_bf16 v[48:63], v[28:31], v[100:103], v[48:63]
    v_mfma_f32_32x32x16_bf16 v[48:63], v[32:35], v[104:107], v[48:63]
    v_mfma_f32_32x32x16_bf16 v[48:63], v[36:39], v[108:111], v[48:63]
    s_waitcnt lgkmcnt(0)
    v_mfma_f32_32x32x16_bf16 v[48:63], v[4:7], v[112:115], v[48:63]
    v_mfma_f32_32x32x16_bf16 v[48:63], v[8:11], v[116:119], v[48:63]
    v_mfma_f32_32x32x16_bf16 v[48:63], v[12:15], v[120:123], v[48:63]
    v_mfma_f32_32x32x16_bf16 v[48:63], v[16:19], v[124:127], v[48:63]
    buffer_load_dword v47, v46, s[28:31], 0 offen sc1
    ds_write_b32 v40, v41 offset:256
KF_TB1:
    ds_read_b32 v134, v133 offset:256
    s_waitcnt lgkmcnt(0)
    v_cmp_ne_u32 vcc, 1, v134
    s_cbranch_vccnz KF_TB1
    s_nop 5
    ds_write_b128 v42, v[48:51] offset:40960
    ds_write_b128 v42, v[52:55] offset:41984
    ds_write_b128 v42, v[56:59] offset:43008
    ds_write_b128 v42, v[60:63] offset:44032
    s_waitcnt lgkmcnt(0)
    ds_write_b32 v40, v41 offset:320
    s_waitcnt vmcnt(0)
    v_readfirstlane_b32 s63, v47
    s_nop 0
    s_cmp_lg_u32 s63, 1
    s_cbranch_scc1 KF_NK0
    s_add_u32 m0, s50, 0
    s_nop 0
    buffer_load_dwordx4 v2, s[4:7], m0 offen sc1 lds
    s_add_u32 m0, s50, 8192
    s_nop 0
    buffer_load_dwordx4 v2, s[4:7], m0 offen sc1 lds
    s_add_u32 m0, s50, 16384
    s_nop 0
    buffer_load_dwordx4 v2, s[4:7], m0 offen sc1 lds
    s_add_u32 m0, s50, 24576
    s_nop 0
    buffer_load_dwordx4 v2, s[4:7], m0 offen sc1 lds
    s_add_u32 m0, s51, 32768
    s_nop 0
    buffer_load_dwordx4 v2, s[4:7], m0 offen sc1 lds
    s_branch KF_NK1
KF_NK0:
    v_mov_b32 v23, 128
    buffer_load_dword v19, v23, s[28:31], 0 offen sc1
KF_NK1:
    v_mov_b32 v12, v21
    v_mov_b32 v13, v20
    v_mov_b32 v14, 0xdddd
    v_mov_b32 v16, v133
    v_mov_b32 v22, v40
    v_mov_b32 v17, 1
    v_mov_b32 v18, 159904
KF_TB2:
    ds_read_b32 v134, v133 offset:320
    s_waitcnt lgkmcnt(0)
    v_cmp_ne_u32 vcc, 1, v134
    s_cbranch_vccnz KF_TB2
    ds_read_b128 v[64:67], v43 offset:40960
    ds_read_b128 v[68:71], v43 offset:41984
    ds_read_b128 v[72:75], v43 offset:43008
    ds_read_b128 v[76:79], v43 offset:44032
    v_mov_b64 v[96:97], 0
    v_mov_b64 v[98:99], 0
    v_mov_b64 v[100:101], 0
    v_mov_b64 v[102:103], 0
    v_mov_b64 v[104:105], 0
    v_mov_b64 v[106:107], 0
    v_mov_b64 v[108:109], 0
    v_mov_b64 v[110:111], 0
    v_mov_b64 v[112:113], 0
    v_mov_b64 v[114:115], 0
    v_mov_b64 v[116:117], 0
    v_mov_b64 v[118:119], 0
    v_mov_b64 v[120:121], 0
    v_mov_b64 v[122:123], 0
    v_mov_b64 v[124:125], 0
    v_mov_b64 v[126:127], 0
    v_mov_b64 v[44:45], 0
    v_mov_b64 v[46:47], 0
    s_waitcnt lgkmcnt(0)
    v_pk_add_f32 v[48:49], v[48:49], v[64:65]
    v_pk_add_f32 v[50:51], v[50:51], v[66:67]
    v_pk_add_f32 v[52:53], v[52:53], v[68:69]
    v_pk_add_f32 v[54:55], v[54:55], v[70:71]
    v_pk_add_f32 v[56:57], v[56:57], v[72:73]
    v_pk_add_f32 v[58:59], v[58:59], v[74:75]
    v_pk_add_f32 v[60:61], v[60:61], v[76:77]
    v_pk_add_f32 v[62:63], v[62:63], v[78:79]
    s_cmp_lg_u32 s38, 0
    s_cbranch_scc1 KF_QSW
    v_cvt_pk_bf16_f32 v4, v48, v49
    v_cvt_pk_bf16_f32 v5, v50, v51
    v_cvt_pk_bf16_f32 v6, v52, v53
    v_cvt_pk_bf16_f32 v7, v54, v55
    v_cvt_pk_bf16_f32 v8, v56, v57
    v_cvt_pk_bf16_f32 v9, v58, v59
    v_cvt_pk_bf16_f32 v10, v60, v61
    v_cvt_pk_bf16_f32 v11, v62, v63
    s_branch KF_QD
KF_QSW:
    v_cvt_pk_bf16_f32 v8, v48, v49
    v_cvt_pk_bf16_f32 v9, v50, v51
    v_cvt_pk_bf16_f32 v10, v52, v53
    v_cvt_pk_bf16_f32 v11, v54, v55
    v_cvt_pk_bf16_f32 v4, v56, v57
    v_cvt_pk_bf16_f32 v5, v58, v59
    v_cvt_pk_bf16_f32 v6, v60, v61
    v_cvt_pk_bf16_f32 v7, v62, v63
KF_QD:
    s_cmp_eq_u32 s63, 1
    s_cbranch_scc1 KF_KVD
    s_waitcnt vmcnt(0)
    v_cmp_gt_u32 vcc, 1, v19
    s_cbranch_vccz KF_KVR
    s_mov_b32 s39, 0
KF_POLL:
    buffer_load_dword v19, v23, s[28:31], 0 offen sc1
    s_add_u32 s39, s39, 1
    s_waitcnt vmcnt(0)
    v_cmp_gt_u32 vcc, 1, v19
    s_cbranch_vccz KF_POLL_OK
    s_sleep 2
    s_cmp_lt_u32 s39, 0x20000
    s_cbranch_scc1 KF_POLL
KF_POLL_OK:
KF_KVR:
    s_add_u32 m0, s50, 0
    s_nop 0
    buffer_load_dwordx4 v2, s[4:7], m0 offen sc1 lds
    s_add_u32 m0, s50, 8192
    s_nop 0
    buffer_load_dwordx4 v2, s[4:7], m0 offen sc1 lds
    s_add_u32 m0, s50, 16384
    s_nop 0
    buffer_load_dwordx4 v2, s[4:7], m0 offen sc1 lds
    s_add_u32 m0, s50, 24576
    s_nop 0
    buffer_load_dwordx4 v2, s[4:7], m0 offen sc1 lds
    s_add_u32 m0, s51, 32768
    s_nop 0
    buffer_load_dwordx4 v2, s[4:7], m0 offen sc1 lds
KF_KVD:
    ds_write_b32 v18, v17
    s_waitcnt vmcnt(0)
    ds_write_b32 v22, v17
KF_C0W:
    ds_read_b32 v19, v16
    s_waitcnt lgkmcnt(0)
    v_cmp_ne_u32 vcc, 1, v19
    s_cbranch_vccnz KF_C0W
    ds_read_b128 v[24:27], v12 offset:0
    ds_read_b128 v[28:31], v13 offset:0
    ds_read_b128 v[32:35], v13 offset:544
    s_waitcnt lgkmcnt(2)
    v_mfma_f32_32x32x16_bf16 v[64:79], v[24:27], v[4:7], 0
    v_mfma_f32_32x32x16_bf16 v[80:95], v[24:27], v[8:11], 0
    s_nop 10
    v_max3_f32 v15, v64, v65, v66
    v_max3_f32 v15, v15, v67, v68
    v_max3_f32 v15, v15, v69, v70
    v_max3_f32 v15, v15, v71, v72
    v_max3_f32 v15, v15, v73, v74
    v_max3_f32 v15, v15, v75, v76
    v_max3_f32 v15, v15, v77, v78
    v_max3_f32 v15, v15, v79, v80
    v_max3_f32 v15, v15, v81, v82
    v_max3_f32 v15, v15, v83, v84
    v_max3_f32 v15, v15, v85, v86
    v_max3_f32 v15, v15, v87, v88
    v_max3_f32 v15, v15, v89, v90
    v_max3_f32 v15, v15, v91, v92
    v_max3_f32 v15, v15, v93, v94
    v_max_f32 v15, v15, v95
    v_mov_b32 v18, v15
    v_mov_b64 v[88:89], 0
    v_mov_b64 v[90:91], 0
    v_mov_b64 v[92:93], 0
    v_mov_b64 v[94:95], 0
    v_permlane32_swap_b32 v18, v15
    v_max_f32 v15, v15, v18
    v_sub_f32 v48, 0, v15
    v_sub_f32 v49, 0, v15
    v_mov_b64 v[50:51], v[48:49]
    v_mov_b64 v[52:53], v[48:49]
    v_mov_b64 v[54:55], v[48:49]
    v_mov_b64 v[56:57], v[48:49]
    v_mov_b64 v[58:59], v[48:49]
    v_mov_b64 v[60:61], v[48:49]
    v_mov_b64 v[62:63], v[48:49]
    s_nop 1
    v_mfma_f32_32x32x16_bf16 v[64:79], v[24:27], v[4:7], v[48:63]
    s_cmp_lt_u32 s32, 4
    s_nop 7
    s_cbranch_scc1 KF_LGO
    s_add_u32 m0, s51, 36864
    s_nop 0
    buffer_load_dwordx4 v2, s[4:7], m0 offen sc1 lds
    s_add_u32 m0, s51, 40960
    s_nop 0
    buffer_load_dwordx4 v2, s[4:7], m0 offen sc1 lds
    s_add_u32 m0, s51, 45056
    s_nop 0
    buffer_load_dwordx4 v2, s[4:7], m0 offen sc1 lds
    s_add_u32 m0, s51, 49152
    s_nop 0
    buffer_load_dwordx4 v2, s[4:7], m0 offen sc1 lds
    s_add_u32 m0, s51, 53248
    s_nop 0
    buffer_load_dwordx4 v2, s[4:7], m0 offen sc1 lds
    s_add_u32 m0, s51, 57344
    s_nop 0
    buffer_load_dwordx4 v2, s[4:7], m0 offen sc1 lds
    s_add_u32 m0, s51, 61440
    s_nop 0
    buffer_load_dwordx4 v2, s[4:7], m0 offen sc1 lds
    s_add_u32 m0, s51, 65536
    s_nop 0
    buffer_load_dwordx4 v2, s[4:7], m0 offen sc1 lds
    s_add_u32 m0, s51, 69632
    s_nop 0
    buffer_load_dwordx4 v2, s[4:7], m0 offen sc1 lds
    s_add_u32 m0, s51, 73728
    s_nop 0
    buffer_load_dwordx4 v2, s[4:7], m0 offen sc1 lds
    s_add_u32 m0, s51, 77824
    s_nop 0
    buffer_load_dwordx4 v2, s[4:7], m0 offen sc1 lds
    s_add_u32 m0, s51, 81920
    s_nop 0
    buffer_load_dwordx4 v2, s[4:7], m0 offen sc1 lds
    s_add_u32 m0, s51, 86016
    s_nop 0
    buffer_load_dwordx4 v2, s[4:7], m0 offen sc1 lds
    s_add_u32 m0, s51, 90112
    s_nop 0
    buffer_load_dwordx4 v2, s[4:7], m0 offen sc1 lds
    s_add_u32 m0, s51, 94208
    s_nop 0
    buffer_load_dwordx4 v2, s[4:7], m0 offen sc1 lds
    s_add_u32 m0, s51, 98304
    s_nop 0
    buffer_load_dwordx4 v2, s[4:7], m0 offen sc1 lds
    s_waitcnt vmcnt(0)
    ds_write_b32 v22, v17 offset:32
    ds_write_b32 v22, v17 offset:16
KF_LGO:
    s_mov_b32 s39, 0
    s_setprio 2
KF_LOOP:
    v_exp_f32 v64, v64
    v_exp_f32 v65, v65
    v_smfmac_f32_32x32x32_bf16 v[112:127], v[44:47], v[88:95], v14
    ds_read_b128 v[36:39], v12 offset:2112
    v_exp_f32 v66, v66
    v_exp_f32 v67, v67
    v_exp_f32 v68, v68
    v_exp_f32 v69, v69
    v_mfma_f32_32x32x16_bf16 v[80:95], v[24:27], v[8:11], v[48:63]
    ds_read_b128 v[40:43], v13 offset:2112
    v_exp_f32 v70, v70
    v_exp_f32 v71, v71
    v_exp_f32 v72, v72
    v_exp_f32 v73, v73
    v_exp_f32 v74, v74
    s_waitcnt lgkmcnt(3)
    v_smfmac_f32_32x32x32_bf16 v[96:111], v[28:31], v[64:71], v14
    v_exp_f32 v75, v75
    v_exp_f32 v76, v76
    v_exp_f32 v77, v77
    v_exp_f32 v78, v78
    v_exp_f32 v79, v79
    v_exp_f32 v80, v80
    v_exp_f32 v81, v81
    s_waitcnt lgkmcnt(2)
    v_smfmac_f32_32x32x32_bf16 v[96:111], v[32:35], v[72:79], v14
    ds_read_b128 v[44:47], v13 offset:2656
    v_exp_f32 v82, v82
    v_exp_f32 v83, v83
    v_exp_f32 v84, v84
    v_exp_f32 v85, v85
    s_waitcnt lgkmcnt(2)
    v_mfma_f32_32x32x16_bf16 v[64:79], v[36:39], v[4:7], v[48:63]
    v_exp_f32 v86, v86
    v_exp_f32 v87, v87
    v_exp_f32 v88, v88
    v_exp_f32 v89, v89
    v_exp_f32 v90, v90
    v_smfmac_f32_32x32x32_bf16 v[112:127], v[28:31], v[80:87], v14
    v_exp_f32 v91, v91
    v_exp_f32 v92, v92
    v_exp_f32 v93, v93
    v_exp_f32 v94, v94
    v_exp_f32 v95, v95
    s_nop 0
    v_exp_f32 v64, v64
    v_exp_f32 v65, v65
    v_smfmac_f32_32x32x32_bf16 v[112:127], v[32:35], v[88:95], v14
    ds_read_b128 v[24:27], v12 offset:4224
    v_exp_f32 v66, v66
    v_exp_f32 v67, v67
    v_exp_f32 v68, v68
    v_exp_f32 v69, v69
    v_mfma_f32_32x32x16_bf16 v[80:95], v[36:39], v[8:11], v[48:63]
    ds_read_b128 v[28:31], v13 offset:4224
    v_exp_f32 v70, v70
    v_exp_f32 v71, v71
    v_exp_f32 v72, v72
    v_exp_f32 v73, v73
    v_exp_f32 v74, v74
    s_waitcnt lgkmcnt(3)
    v_smfmac_f32_32x32x32_bf16 v[96:111], v[40:43], v[64:71], v14
    v_exp_f32 v75, v75
    v_exp_f32 v76, v76
    v_exp_f32 v77, v77
    v_exp_f32 v78, v78
    v_exp_f32 v79, v79
    v_exp_f32 v80, v80
    v_exp_f32 v81, v81
    s_waitcnt lgkmcnt(2)
    v_smfmac_f32_32x32x32_bf16 v[96:111], v[44:47], v[72:79], v14
    ds_read_b128 v[32:35], v13 offset:4768
    v_exp_f32 v82, v82
    v_exp_f32 v83, v83
    v_exp_f32 v84, v84
    v_exp_f32 v85, v85
    s_waitcnt lgkmcnt(2)
    v_mfma_f32_32x32x16_bf16 v[64:79], v[24:27], v[4:7], v[48:63]
    v_exp_f32 v86, v86
    v_exp_f32 v87, v87
    v_exp_f32 v88, v88
    v_exp_f32 v89, v89
    v_exp_f32 v90, v90
    v_smfmac_f32_32x32x32_bf16 v[112:127], v[40:43], v[80:87], v14
    v_exp_f32 v91, v91
    v_exp_f32 v92, v92
    v_exp_f32 v93, v93
    v_exp_f32 v94, v94
    v_exp_f32 v95, v95
    s_nop 0
    v_exp_f32 v64, v64
    v_exp_f32 v65, v65
    v_smfmac_f32_32x32x32_bf16 v[112:127], v[44:47], v[88:95], v14
    ds_read_b128 v[36:39], v12 offset:6336
    v_exp_f32 v66, v66
    v_exp_f32 v67, v67
    v_exp_f32 v68, v68
    v_exp_f32 v69, v69
    v_mfma_f32_32x32x16_bf16 v[80:95], v[24:27], v[8:11], v[48:63]
    ds_read_b128 v[40:43], v13 offset:6336
    v_exp_f32 v70, v70
    v_exp_f32 v71, v71
    v_exp_f32 v72, v72
    v_exp_f32 v73, v73
    v_exp_f32 v74, v74
    s_waitcnt lgkmcnt(3)
    v_smfmac_f32_32x32x32_bf16 v[96:111], v[28:31], v[64:71], v14
    v_exp_f32 v75, v75
    v_exp_f32 v76, v76
    v_exp_f32 v77, v77
    v_exp_f32 v78, v78
    v_exp_f32 v79, v79
    v_exp_f32 v80, v80
    v_exp_f32 v81, v81
    s_waitcnt lgkmcnt(2)
    v_smfmac_f32_32x32x32_bf16 v[96:111], v[32:35], v[72:79], v14
    ds_read_b128 v[44:47], v13 offset:6880
    v_exp_f32 v82, v82
    v_exp_f32 v83, v83
    v_exp_f32 v84, v84
    v_exp_f32 v85, v85
    s_waitcnt lgkmcnt(2)
    v_mfma_f32_32x32x16_bf16 v[64:79], v[36:39], v[4:7], v[48:63]
    v_exp_f32 v86, v86
    v_exp_f32 v87, v87
    v_exp_f32 v88, v88
    v_exp_f32 v89, v89
    v_exp_f32 v90, v90
    v_smfmac_f32_32x32x32_bf16 v[112:127], v[28:31], v[80:87], v14
    v_exp_f32 v91, v91
    v_exp_f32 v92, v92
    v_exp_f32 v93, v93
    v_exp_f32 v94, v94
    v_exp_f32 v95, v95
    s_nop 0
    v_exp_f32 v64, v64
    v_exp_f32 v65, v65
    v_smfmac_f32_32x32x32_bf16 v[112:127], v[32:35], v[88:95], v14
    ds_read_b128 v[24:27], v12 offset:8448
    v_exp_f32 v66, v66
    v_exp_f32 v67, v67
    v_exp_f32 v68, v68
    v_exp_f32 v69, v69
    v_mfma_f32_32x32x16_bf16 v[80:95], v[36:39], v[8:11], v[48:63]
    ds_read_b128 v[28:31], v13 offset:8448
    v_exp_f32 v70, v70
    v_exp_f32 v71, v71
    v_exp_f32 v72, v72
    v_exp_f32 v73, v73
    v_exp_f32 v74, v74
    s_waitcnt lgkmcnt(3)
    v_smfmac_f32_32x32x32_bf16 v[96:111], v[40:43], v[64:71], v14
    v_exp_f32 v75, v75
    v_exp_f32 v76, v76
    v_exp_f32 v77, v77
    v_exp_f32 v78, v78
    v_exp_f32 v79, v79
    v_exp_f32 v80, v80
    v_exp_f32 v81, v81
    s_waitcnt lgkmcnt(2)
    v_smfmac_f32_32x32x32_bf16 v[96:111], v[44:47], v[72:79], v14
    ds_read_b128 v[32:35], v13 offset:8992
    v_exp_f32 v82, v82
    v_exp_f32 v83, v83
    v_exp_f32 v84, v84
    v_exp_f32 v85, v85
    s_waitcnt lgkmcnt(2)
    v_mfma_f32_32x32x16_bf16 v[64:79], v[24:27], v[4:7], v[48:63]
    v_exp_f32 v86, v86
    v_exp_f32 v87, v87
    v_exp_f32 v88, v88
    v_exp_f32 v89, v89
    v_exp_f32 v90, v90
    v_smfmac_f32_32x32x32_bf16 v[112:127], v[40:43], v[80:87], v14
    v_exp_f32 v91, v91
    v_exp_f32 v92, v92
    v_exp_f32 v93, v93
    v_exp_f32 v94, v94
    v_exp_f32 v95, v95
    s_nop 0
    v_exp_f32 v64, v64
    v_exp_f32 v65, v65
    v_smfmac_f32_32x32x32_bf16 v[112:127], v[44:47], v[88:95], v14
    ds_read_b128 v[36:39], v12 offset:10560
    v_exp_f32 v66, v66
    v_exp_f32 v67, v67
    v_exp_f32 v68, v68
    v_exp_f32 v69, v69
    v_mfma_f32_32x32x16_bf16 v[80:95], v[24:27], v[8:11], v[48:63]
    ds_read_b128 v[40:43], v13 offset:10560
    v_exp_f32 v70, v70
    v_exp_f32 v71, v71
    v_exp_f32 v72, v72
    v_exp_f32 v73, v73
    v_exp_f32 v74, v74
    s_waitcnt lgkmcnt(3)
    v_smfmac_f32_32x32x32_bf16 v[96:111], v[28:31], v[64:71], v14
    v_exp_f32 v75, v75
    v_exp_f32 v76, v76
    v_exp_f32 v77, v77
    v_exp_f32 v78, v78
    v_exp_f32 v79, v79
    v_exp_f32 v80, v80
    v_exp_f32 v81, v81
    s_waitcnt lgkmcnt(2)
    v_smfmac_f32_32x32x32_bf16 v[96:111], v[32:35], v[72:79], v14
    ds_read_b128 v[44:47], v13 offset:11104
    v_exp_f32 v82, v82
    v_exp_f32 v83, v83
    v_exp_f32 v84, v84
    v_exp_f32 v85, v85
    s_waitcnt lgkmcnt(2)
    v_mfma_f32_32x32x16_bf16 v[64:79], v[36:39], v[4:7], v[48:63]
    v_exp_f32 v86, v86
    v_exp_f32 v87, v87
    v_exp_f32 v88, v88
    v_exp_f32 v89, v89
    v_exp_f32 v90, v90
    v_smfmac_f32_32x32x32_bf16 v[112:127], v[28:31], v[80:87], v14
    v_exp_f32 v91, v91
    v_exp_f32 v92, v92
    v_exp_f32 v93, v93
    v_exp_f32 v94, v94
    v_exp_f32 v95, v95
    s_nop 0
    v_exp_f32 v64, v64
    v_exp_f32 v65, v65
    v_smfmac_f32_32x32x32_bf16 v[112:127], v[32:35], v[88:95], v14
    ds_read_b128 v[24:27], v12 offset:12672
    v_exp_f32 v66, v66
    v_exp_f32 v67, v67
    v_exp_f32 v68, v68
    v_exp_f32 v69, v69
    v_mfma_f32_32x32x16_bf16 v[80:95], v[36:39], v[8:11], v[48:63]
    ds_read_b128 v[28:31], v13 offset:12672
    v_exp_f32 v70, v70
    v_exp_f32 v71, v71
    v_exp_f32 v72, v72
    v_exp_f32 v73, v73
    v_exp_f32 v74, v74
    s_waitcnt lgkmcnt(3)
    v_smfmac_f32_32x32x32_bf16 v[96:111], v[40:43], v[64:71], v14
    v_exp_f32 v75, v75
    v_exp_f32 v76, v76
    v_exp_f32 v77, v77
    v_exp_f32 v78, v78
    v_exp_f32 v79, v79
    v_exp_f32 v80, v80
    v_exp_f32 v81, v81
    s_waitcnt lgkmcnt(2)
    v_smfmac_f32_32x32x32_bf16 v[96:111], v[44:47], v[72:79], v14
    ds_read_b128 v[32:35], v13 offset:13216
    v_exp_f32 v82, v82
    v_exp_f32 v83, v83
    v_exp_f32 v84, v84
    v_exp_f32 v85, v85
    s_waitcnt lgkmcnt(2)
    v_mfma_f32_32x32x16_bf16 v[64:79], v[24:27], v[4:7], v[48:63]
    v_exp_f32 v86, v86
    v_exp_f32 v87, v87
    v_exp_f32 v88, v88
    v_exp_f32 v89, v89
    v_exp_f32 v90, v90
    v_smfmac_f32_32x32x32_bf16 v[112:127], v[40:43], v[80:87], v14
    v_exp_f32 v91, v91
    v_exp_f32 v92, v92
    v_exp_f32 v93, v93
    v_exp_f32 v94, v94
    v_exp_f32 v95, v95
    s_nop 0
    v_exp_f32 v64, v64
    v_exp_f32 v65, v65
    v_smfmac_f32_32x32x32_bf16 v[112:127], v[44:47], v[88:95], v14
    ds_read_b128 v[36:39], v12 offset:14784
    v_exp_f32 v66, v66
    v_exp_f32 v67, v67
    v_exp_f32 v68, v68
    v_exp_f32 v69, v69
    v_mfma_f32_32x32x16_bf16 v[80:95], v[24:27], v[8:11], v[48:63]
    ds_read_b128 v[40:43], v13 offset:14784
    v_exp_f32 v70, v70
    v_exp_f32 v71, v71
    v_exp_f32 v72, v72
    v_exp_f32 v73, v73
    v_exp_f32 v74, v74
    s_waitcnt lgkmcnt(3)
    v_smfmac_f32_32x32x32_bf16 v[96:111], v[28:31], v[64:71], v14
    v_exp_f32 v75, v75
    v_exp_f32 v76, v76
    v_exp_f32 v77, v77
    v_exp_f32 v78, v78
    v_exp_f32 v79, v79
    v_exp_f32 v80, v80
    v_exp_f32 v81, v81
    s_waitcnt lgkmcnt(2)
    v_smfmac_f32_32x32x32_bf16 v[96:111], v[32:35], v[72:79], v14
    ds_read_b32 v19, v16 offset:32
    ds_read_b128 v[44:47], v13 offset:15328
    v_exp_f32 v82, v82
    v_exp_f32 v83, v83
    v_exp_f32 v84, v84
    v_exp_f32 v85, v85
    s_waitcnt lgkmcnt(3)
    v_mfma_f32_32x32x16_bf16 v[64:79], v[36:39], v[4:7], v[48:63]
    v_exp_f32 v86, v86
    v_exp_f32 v87, v87
    v_exp_f32 v88, v88
    v_exp_f32 v89, v89
    v_exp_f32 v90, v90
    v_smfmac_f32_32x32x32_bf16 v[112:127], v[28:31], v[80:87], v14
    v_exp_f32 v91, v91
    v_exp_f32 v92, v92
    v_exp_f32 v93, v93
    v_exp_f32 v94, v94
    v_exp_f32 v95, v95
    s_nop 0
    v_exp_f32 v64, v64
    v_exp_f32 v65, v65
    v_smfmac_f32_32x32x32_bf16 v[112:127], v[32:35], v[88:95], v14
    s_waitcnt lgkmcnt(1)
    v_cmp_ne_u32 vcc, 1, v19
    s_cbranch_vccnz KF_SPIN
KF_SPUN:
    ds_read_b128 v[24:27], v12 offset:33792
    v_exp_f32 v66, v66
    v_exp_f32 v67, v67
    v_exp_f32 v68, v68
    v_exp_f32 v69, v69
    v_mfma_f32_32x32x16_bf16 v[80:95], v[36:39], v[8:11], v[48:63]
    ds_read_b128 v[28:31], v13 offset:33792
    v_exp_f32 v70, v70
    v_exp_f32 v71, v71
    v_exp_f32 v72, v72
    v_exp_f32 v73, v73
    v_exp_f32 v74, v74
    s_waitcnt lgkmcnt(3)
    v_smfmac_f32_32x32x32_bf16 v[96:111], v[40:43], v[64:71], v14
    v_exp_f32 v75, v75
    v_exp_f32 v76, v76
    v_exp_f32 v77, v77
    v_exp_f32 v78, v78
    v_exp_f32 v79, v79
    v_exp_f32 v80, v80
    v_exp_f32 v81, v81
    s_waitcnt lgkmcnt(2)
    v_smfmac_f32_32x32x32_bf16 v[96:111], v[44:47], v[72:79], v14
    ds_read_b128 v[32:35], v13 offset:34336
    v_exp_f32 v82, v82
    v_exp_f32 v83, v83
    v_exp_f32 v84, v84
    v_exp_f32 v85, v85
    s_waitcnt lgkmcnt(2)
    v_mfma_f32_32x32x16_bf16 v[64:79], v[24:27], v[4:7], v[48:63]
    v_exp_f32 v86, v86
    v_exp_f32 v87, v87
    v_exp_f32 v88, v88
    v_exp_f32 v89, v89
    v_exp_f32 v90, v90
    v_smfmac_f32_32x32x32_bf16 v[112:127], v[40:43], v[80:87], v14
    v_add_u32 v12, 33792, v12
    v_add_u32 v13, 33792, v13
    v_add_u32 v16, 32, v16
    s_add_u32 s39, s39, 1
    s_cmp_lg_u32 s39, 2
    s_cbranch_scc1 KF_PR1
    s_setprio 1
    ds_write_b32 v22, v17 offset:352
KF_PR1:
    s_cmp_lg_u32 s39, 3
    s_cbranch_scc1 KF_PR2
    s_setprio 0
KF_PR2:
    s_cmp_lt_u32 s39, 4
    v_exp_f32 v91, v91
    v_exp_f32 v92, v92
    v_exp_f32 v93, v93
    v_exp_f32 v94, v94
    v_exp_f32 v95, v95
    s_cbranch_scc1 KF_LOOP
    s_nop 0
    v_smfmac_f32_32x32x32_bf16 v[112:127], v[44:47], v[88:95], v14
    s_mov_b32 s35, 0x53800000
    s_mov_b32 s36, 0x2b800000
    s_nop 9
    v_min_f32 v65, v104, v120
    v_add_f32 v66, v104, v120
    v_cmp_nge_f32 vcc, s35, v66
    v_cmp_nle_f32 s[62:63], s36, v65
    s_nop 0
    s_or_b64 vcc, vcc, s[62:63]
    s_cbranch_vccnz KF_FALLBACK
    v_mov_b32 v121, v15
KF_FIN2:
    ds_write_b128 v159, v[112:115]
    ds_write_b128 v159, v[116:119] offset:1024
    ds_write_b64 v159, v[120:121] offset:2048
    s_cmp_ge_u32 s32, 4
    s_cbranch_scc1 KF_NWB
KF_WBW:
    ds_read_b32 v134, v133 offset:352
    s_waitcnt lgkmcnt(0)
    v_cmp_ne_u32 vcc, 1, v134
    s_cbranch_vccnz KF_WBW
    s_add_u32 m0, s50, 0
    s_add_u32 s35, s49, 0
    buffer_load_dwordx4 v138, s[76:79], s35 offen lds
    s_add_u32 m0, s50, 4096
    s_add_u32 s35, s49, 32768
    buffer_load_dwordx4 v138, s[76:79], s35 offen lds
    s_add_u32 m0, s50, 8192
    s_add_u32 s35, s49, 65536
    buffer_load_dwordx4 v138, s[76:79], s35 offen lds
    s_add_u32 m0, s50, 12288
    s_add_u32 s35, s49, 98304
    buffer_load_dwordx4 v138, s[76:79], s35 offen lds
    s_add_u32 m0, s50, 16384
    s_add_u32 s35, s49, 131072
    buffer_load_dwordx4 v138, s[76:79], s35 offen lds
    s_add_u32 m0, s50, 20480
    s_add_u32 s35, s49, 163840
    buffer_load_dwordx4 v138, s[76:79], s35 offen lds
    s_add_u32 m0, s50, 24576
    s_add_u32 s35, s49, 196608
    buffer_load_dwordx4 v138, s[76:79], s35 offen lds
    s_add_u32 m0, s50, 28672
    s_add_u32 s35, s49, 229376
    buffer_load_dwordx4 v138, s[76:79], s35 offen lds
    s_add_u32 m0, s50, 32768
    s_add_u32 s35, s49, 262144
    buffer_load_dwordx4 v138, s[76:79], s35 offen lds
    s_add_u32 m0, s50, 36864
    s_add_u32 s35, s49, 294912
    buffer_load_dwordx4 v138, s[76:79], s35 offen lds
    s_add_u32 m0, s50, 40960
    s_add_u32 s35, s49, 327680
    buffer_load_dwordx4 v138, s[76:79], s35 offen lds
    s_add_u32 m0, s50, 45056
    s_add_u32 s35, s49, 360448
    buffer_load_dwordx4 v138, s[76:79], s35 offen lds
    s_add_u32 m0, s50, 49152
    s_add_u32 s35, s49, 393216
    buffer_load_dwordx4 v138, s[76:79], s35 offen lds
    s_add_u32 m0, s50, 53248
    s_add_u32 s35, s49, 425984
    buffer_load_dwordx4 v138, s[76:79], s35 offen lds
    s_add_u32 m0, s50, 57344
    s_add_u32 s35, s49, 458752
    buffer_load_dwordx4 v138, s[76:79], s35 offen lds
    s_add_u32 m0, s50, 61440
    s_add_u32 s35, s49, 491520
    buffer_load_dwordx4 v138, s[76:79], s35 offen lds
KF_NWB:
    s_waitcnt lgkmcnt(0)
    s_barrier
    ds_read_b64 v[72:73], v160 offset:2048
    ds_read_b128 v[64:67], v160
    ds_read_b128 v[68:71], v160 offset:1024
    s_waitcnt lgkmcnt(2)
    v_max_f32 v18, v73, v15
    v_sub_f32 v82, v73, v18
    v_sub_f32 v80, v15, v18
    v_exp_f32 v82, v82
    v_exp_f32 v80, v80
    v_mul_f32 v18, v72, v82
    v_fmac_f32 v18, v104, v80
    v_rcp_f32 v18, v18
    s_nop 0
    v_mul_f32 v80, v80, v18
    v_mul_f32 v82, v82, v18
    v_pk_mul_f32 v[96:97], v[96:97], v[80:81] op_sel_hi:[1,0]
    v_pk_mul_f32 v[98:99], v[98:99], v[80:81] op_sel_hi:[1,0]
    v_pk_mul_f32 v[100:101], v[100:101], v[80:81] op_sel_hi:[1,0]
    v_pk_mul_f32 v[102:103], v[102:103], v[80:81] op_sel_hi:[1,0]
    s_waitcnt lgkmcnt(0)
    v_pk_fma_f32 v[96:97], v[64:65], v[82:83], v[96:97] op_sel_hi:[1,0,1]
    v_pk_fma_f32 v[98:99], v[66:67], v[82:83], v[98:99] op_sel_hi:[1,0,1]
    v_pk_fma_f32 v[100:101], v[68:69], v[82:83], v[100:101] op_sel_hi:[1,0,1]
    v_pk_fma_f32 v[102:103], v[70:71], v[82:83], v[102:103] op_sel_hi:[1,0,1]
    v_cvt_pk_bf16_f32 v24, v96, v97
    v_cvt_pk_bf16_f32 v25, v98, v99
    v_cvt_pk_bf16_f32 v26, v100, v101
    v_cvt_pk_bf16_f32 v27, v102, v103
    buffer_store_dwordx4 v[24:27], v2, s[4:7], s40 offen sc1
    s_cmp_lg_u32 s32, 1
    s_cbranch_scc1 KF_TA
    buffer_load_dword v19, v165, s[4:7], s60 offen sc1
KF_TA:
    s_waitcnt vmcnt(0)
    s_barrier
    s_cmp_lg_u32 s32, 0
    s_cbranch_scc1 KF_T0
    buffer_store_dword v17, v164, s[4:7], s60 offen sc1
KF_T0:
    s_cmp_lg_u32 s32, 1
    s_cbranch_scc1 KF_T1
    v_cmp_gt_u32 vcc, 1, v19
    s_cbranch_vccz KF_T1
    s_mov_b32 s39, 0
KF_TP:
    buffer_load_dword v19, v165, s[4:7], s60 offen sc1
    s_add_u32 s39, s39, 1
    s_waitcnt vmcnt(0)
    v_cmp_gt_u32 vcc, 1, v19
    s_cbranch_vccz KF_TP_OK
    s_sleep 1
    s_cmp_lt_u32 s39, 0x20000
    s_cbranch_scc1 KF_TP
KF_TP_OK:
KF_T1:
KF_T1B:
    s_barrier
    s_add_u32 m0, s50, 65536
    s_add_u32 s35, s53, 0
    buffer_load_dwordx4 v2, s[4:7], s35 offen sc1 lds
    s_add_u32 m0, s50, 81920
    s_add_u32 s35, s53, 16384
    buffer_load_dwordx4 v2, s[4:7], s35 offen sc1 lds
    s_add_u32 m0, s50, 98304
    s_add_u32 s35, s53, 32768
    buffer_load_dwordx4 v2, s[4:7], s35 offen sc1 lds
    s_add_u32 m0, s50, 114688
    s_add_u32 s35, s53, 49152
    buffer_load_dwordx4 v2, s[4:7], s35 offen sc1 lds
    s_add_u32 m0, s50, 73728
    s_add_u32 s35, s53, 8192
    buffer_load_dwordx4 v2, s[4:7], s35 offen sc1 lds
    s_add_u32 m0, s50, 90112
    s_add_u32 s35, s53, 24576
    buffer_load_dwordx4 v2, s[4:7], s35 offen sc1 lds
    s_add_u32 m0, s50, 106496
    s_add_u32 s35, s53, 40960
    buffer_load_dwordx4 v2, s[4:7], s35 offen sc1 lds
    s_add_u32 m0, s50, 122880
    s_add_u32 s35, s53, 57344
    buffer_load_dwordx4 v2, s[4:7], s35 offen sc1 lds
    ds_read_b64_tr_b16 v[64:65], v147 offset:0
    ds_read_b64_tr_b16 v[66:67], v147 offset:1024
    ds_read_b64_tr_b16 v[68:69], v147 offset:2048
    ds_read_b64_tr_b16 v[70:71], v147 offset:3072
    ds_read_b64_tr_b16 v[72:73], v147 offset:4096
    ds_read_b64_tr_b16 v[74:75], v147 offset:5120
    ds_read_b64_tr_b16 v[76:77], v147 offset:6144
    ds_read_b64_tr_b16 v[78:79], v147 offset:7168
    ds_read_b64_tr_b16 v[80:81], v147 offset:8192
    ds_read_b64_tr_b16 v[82:83], v147 offset:9216
    ds_read_b64_tr_b16 v[84:85], v147 offset:10240
    ds_read_b64_tr_b16 v[86:87], v147 offset:11264
    ds_read_b64_tr_b16 v[88:89], v147 offset:12288
    ds_read_b64_tr_b16 v[90:91], v147 offset:13312
    ds_read_b64_tr_b16 v[92:93], v147 offset:14336
    ds_read_b64_tr_b16 v[94:95], v147 offset:15360
    ds_read_b64_tr_b16 v[96:97], v147 offset:16384
    ds_read_b64_tr_b16 v[98:99], v147 offset:17408
    ds_read_b64_tr_b16 v[100:101], v147 offset:18432
    ds_read_b64_tr_b16 v[102:103], v147 offset:19456
    ds_read_b64_tr_b16 v[104:105], v147 offset:20480
    ds_read_b64_tr_b16 v[106:107], v147 offset:21504
    ds_read_b64_tr_b16 v[108:109], v147 offset:22528
    ds_read_b64_tr_b16 v[110:111], v147 offset:23552
    ds_read_b64_tr_b16 v[112:113], v147 offset:24576
    ds_read_b64_tr_b16 v[114:115], v147 offset:25600
    ds_read_b64_tr_b16 v[116:117], v147 offset:26624
    ds_read_b64_tr_b16 v[118:119], v147 offset:27648
    ds_read_b64_tr_b16 v[120:121], v147 offset:28672
    ds_read_b64_tr_b16 v[122:123], v147 offset:29696
    ds_read_b64_tr_b16 v[124:125], v147 offset:30720
    ds_read_b64_tr_b16 v[126:127], v147 offset:31744
    s_waitcnt vmcnt(4)
    s_barrier
    ds_read_b128 v[4:7], v162 offset:0
    ds_read_b128 v[8:11], v162 offset:1024
    ds_read_b128 v[12:15], v162 offset:2048
    ds_read_b128 v[16:19], v162 offset:3072
    ds_read_b128 v[24:27], v162 offset:4096
    ds_read_b128 v[28:31], v162 offset:5120
    ds_read_b128 v[32:35], v162 offset:6144
    ds_read_b128 v[36:39], v162 offset:7168
    s_waitcnt lgkmcnt(7)
    v_mfma_f32_32x32x16_bf16 v[48:63], v[64:67], v[4:7], 0
    s_waitcnt lgkmcnt(6)
    v_mfma_f32_32x32x16_bf16 v[48:63], v[68:71], v[8:11], v[48:63]
    s_waitcnt lgkmcnt(5)
    v_mfma_f32_32x32x16_bf16 v[48:63], v[72:75], v[12:15], v[48:63]
    s_waitcnt lgkmcnt(4)
    v_mfma_f32_32x32x16_bf16 v[48:63], v[76:79], v[16:19], v[48:63]
    s_waitcnt lgkmcnt(3)
    v_mfma_f32_32x32x16_bf16 v[48:63], v[80:83], v[24:27], v[48:63]
    s_waitcnt lgkmcnt(2)
    v_mfma_f32_32x32x16_bf16 v[48:63], v[84:87], v[28:31], v[48:63]
    s_waitcnt lgkmcnt(1)
    v_mfma_f32_32x32x16_bf16 v[48:63], v[88:91], v[32:35], v[48:63]
    s_waitcnt lgkmcnt(0)
    v_mfma_f32_32x32x16_bf16 v[48:63], v[92:95], v[36:39], v[48:63]
    s_waitcnt vmcnt(0)
    s_barrier
    ds_read_b128 v[4:7], v162 offset:8192
    ds_read_b128 v[8:11], v162 offset:9216
    ds_read_b128 v[12:15], v162 offset:10240
    ds_read_b128 v[16:19], v162 offset:11264
    ds_read_b128 v[24:27], v162 offset:12288
    ds_read_b128 v[28:31], v162 offset:13312
    ds_read_b128 v[32:35], v162 offset:14336
    ds_read_b128 v[36:39], v162 offset:15360
    s_waitcnt lgkmcnt(7)
    v_mfma_f32_32x32x16_bf16 v[48:63], v[96:99], v[4:7], v[48:63]
    s_waitcnt lgkmcnt(6)
    v_mfma_f32_32x32x16_bf16 v[48:63], v[100:103], v[8:11], v[48:63]
    s_waitcnt lgkmcnt(5)
    v_mfma_f32_32x32x16_bf16 v[48:63], v[104:107], v[12:15], v[48:63]
    s_waitcnt lgkmcnt(4)
    v_mfma_f32_32x32x16_bf16 v[48:63], v[108:111], v[16:19], v[48:63]
    s_waitcnt lgkmcnt(3)
    v_mfma_f32_32x32x16_bf16 v[48:63], v[112:115], v[24:27], v[48:63]
    s_waitcnt lgkmcnt(2)
    v_mfma_f32_32x32x16_bf16 v[48:63], v[116:119], v[28:31], v[48:63]
    s_waitcnt lgkmcnt(1)
    v_mfma_f32_32x32x16_bf16 v[48:63], v[120:123], v[32:35], v[48:63]
    s_waitcnt lgkmcnt(0)
    v_mfma_f32_32x32x16_bf16 v[48:63], v[124:127], v[36:39], v[48:63]
    s_nop 11
    ds_write_b128 v140, v[48:51]
    ds_write_b128 v141, v[52:55]
    ds_write_b128 v142, v[56:59]
    ds_write_b128 v143, v[60:63]
    s_waitcnt lgkmcnt(0)
    s_barrier
    ds_read_b128 v[64:67], v144
    ds_read_b128 v[68:71], v145
    ds_read_b128 v[72:75], v144 offset:16384
    ds_read_b128 v[76:79], v145 offset:16384
    s_waitcnt lgkmcnt(0)
    v_pk_add_f32 v[64:65], v[64:65], v[72:73]
    v_pk_add_f32 v[66:67], v[66:67], v[74:75]
    v_pk_add_f32 v[68:69], v[68:69], v[76:77]
    v_pk_add_f32 v[70:71], v[70:71], v[78:79]
    v_cvt_pk_bf16_f32 v4, v64, v65
    v_cvt_pk_bf16_f32 v5, v66, v67
    v_cvt_pk_bf16_f32 v6, v68, v69
    v_cvt_pk_bf16_f32 v7, v70, v71
    buffer_store_dwordx4 v[4:7], v146, s[68:71], s58 offen sc1
    s_endpgm
KF_SPIN:
    s_sleep 2
    ds_read_b32 v19, v16 offset:32
    s_waitcnt lgkmcnt(0)
    v_cmp_ne_u32 vcc, 1, v19
    s_cbranch_vccnz KF_SPIN
    s_branch KF_SPUN
KF_FALLBACK:
    s_waitcnt lgkmcnt(0)
    v_mov_b32 v36, 0xff800000
    v_mov_b32 v37, 0xff800000
    v_mov_b32 v12, v21
    s_mov_b32 s39, 0
KF_FB1:
    buffer_load_dwordx4 v[24:27], v12, s[4:7], 0 offen sc1
    s_and_b32 s35, s39, 7
    s_cmp_eq_u32 s35, 7
    s_mov_b32 s35, 2112
    s_cselect_b32 s35, 19008, s35
    v_add_u32 v12, s35, v12
    s_waitcnt vmcnt(0)
    v_mfma_f32_32x32x16_bf16 v[64:79], v[24:27], v[4:7], 0
    v_mfma_f32_32x32x16_bf16 v[80:95], v[24:27], v[8:11], 0
    s_nop 10
    v_max3_f32 v36, v36, v64, v65
    v_max3_f32 v36, v36, v66, v67
    v_max3_f32 v36, v36, v68, v69
    v_max3_f32 v36, v36, v70, v71
    v_max3_f32 v36, v36, v72, v73
    v_max3_f32 v36, v36, v74, v75
    v_max3_f32 v36, v36, v76, v77
    v_max3_f32 v36, v36, v78, v79
    v_max3_f32 v37, v37, v80, v81
    v_max3_f32 v37, v37, v82, v83
    v_max3_f32 v37, v37, v84, v85
    v_max3_f32 v37, v37, v86, v87
    v_max3_f32 v37, v37, v88, v89
    v_max3_f32 v37, v37, v90, v91
    v_max3_f32 v37, v37, v92, v93
    v_max3_f32 v37, v37, v94, v95
    s_add_u32 s39, s39, 1
    s_cmp_lt_u32 s39, 32
    s_cbranch_scc1 KF_FB1
    v_mov_b32 v64, v36
    s_nop 1
    v_permlane32_swap_b32 v64, v36
    v_max_f32 v36, v36, v64
    v_mov_b32 v64, v37
    s_nop 1
    v_permlane32_swap_b32 v64, v37
    v_max_f32 v37, v37, v64
    v_mov_b64 v[96:97], 0
    v_mov_b64 v[98:99], 0
    v_mov_b64 v[100:101], 0
    v_mov_b64 v[102:103], 0
    v_mov_b64 v[104:105], 0
    v_mov_b64 v[106:107], 0
    v_mov_b64 v[108:109], 0
    v_mov_b64 v[110:111], 0
    v_mov_b64 v[112:113], 0
    v_mov_b64 v[114:115], 0
    v_mov_b64 v[116:117], 0
    v_mov_b64 v[118:119], 0
    v_mov_b64 v[120:121], 0
    v_mov_b64 v[122:123], 0
    v_mov_b64 v[124:125], 0
    v_mov_b64 v[126:127], 0
    v_mov_b32 v12, v21
    v_mov_b32 v13, v20
    s_mov_b32 s39, 0
KF_FB2:
    buffer_load_dwordx4 v[24:27], v12, s[4:7], 0 offen sc1
    buffer_load_dwordx4 v[28:31], v13, s[4:7], 0 offen sc1
    buffer_load_dwordx4 v[32:35], v13, s[4:7], 0 offen offset:544 sc1
    s_and_b32 s35, s39, 7
    s_cmp_eq_u32 s35, 7
    s_mov_b32 s35, 2112
    s_cselect_b32 s35, 19008, s35
    v_add_u32 v12, s35, v12
    v_add_u32 v13, s35, v13
    s_waitcnt vmcnt(0)
    v_mfma_f32_32x32x16_bf16 v[64:79], v[24:27], v[4:7], 0
    v_mfma_f32_32x32x16_bf16 v[80:95], v[24:27], v[8:11], 0
    s_nop 10
    v_sub_f32 v64, v64, v36
    v_sub_f32 v65, v65, v36
    v_sub_f32 v66, v66, v36
    v_sub_f32 v67, v67, v36
    v_sub_f32 v68, v68, v36
    v_sub_f32 v69, v69, v36
    v_sub_f32 v70, v70, v36
    v_sub_f32 v71, v71, v36
    v_sub_f32 v72, v72, v36
    v_sub_f32 v73, v73, v36
    v_sub_f32 v74, v74, v36
    v_sub_f32 v75, v75, v36
    v_sub_f32 v76, v76, v36
    v_sub_f32 v77, v77, v36
    v_sub_f32 v78, v78, v36
    v_sub_f32 v79, v79, v36
    v_exp_f32 v64, v64
    v_exp_f32 v65, v65
    v_exp_f32 v66, v66
    v_exp_f32 v67, v67
    v_exp_f32 v68, v68
    v_exp_f32 v69, v69
    v_exp_f32 v70, v70
    v_exp_f32 v71, v71
    v_exp_f32 v72, v72
    v_exp_f32 v73, v73
    v_exp_f32 v74, v74
    v_exp_f32 v75, v75
    v_exp_f32 v76, v76
    v_exp_f32 v77, v77
    v_exp_f32 v78, v78
    v_exp_f32 v79, v79
    v_smfmac_f32_32x32x32_bf16 v[96:111], v[28:31], v[64:71], v14
    s_nop 0
    v_smfmac_f32_32x32x32_bf16 v[96:111], v[32:35], v[72:79], v14
    v_sub_f32 v80, v80, v37
    v_sub_f32 v81, v81, v37
    v_sub_f32 v82, v82, v37
    v_sub_f32 v83, v83, v37
    v_sub_f32 v84, v84, v37
    v_sub_f32 v85, v85, v37
    v_sub_f32 v86, v86, v37
    v_sub_f32 v87, v87, v37
    v_sub_f32 v88, v88, v37
    v_sub_f32 v89, v89, v37
    v_sub_f32 v90, v90, v37
    v_sub_f32 v91, v91, v37
    v_sub_f32 v92, v92, v37
    v_sub_f32 v93, v93, v37
    v_sub_f32 v94, v94, v37
    v_sub_f32 v95, v95, v37
    v_exp_f32 v80, v80
    v_exp_f32 v81, v81
    v_exp_f32 v82, v82
    v_exp_f32 v83, v83
    v_exp_f32 v84, v84
    v_exp_f32 v85, v85
    v_exp_f32 v86, v86
    v_exp_f32 v87, v87
    v_exp_f32 v88, v88
    v_exp_f32 v89, v89
    v_exp_f32 v90, v90
    v_exp_f32 v91, v91
    v_exp_f32 v92, v92
    v_exp_f32 v93, v93
    v_exp_f32 v94, v94
    v_exp_f32 v95, v95
    v_smfmac_f32_32x32x32_bf16 v[112:127], v[28:31], v[80:87], v14
    s_nop 0
    v_smfmac_f32_32x32x32_bf16 v[112:127], v[32:35], v[88:95], v14
    s_add_u32 s39, s39, 1
    s_cmp_lt_u32 s39, 32
    s_cbranch_scc1 KF_FB2
    v_mov_b32 v15, v36
    s_nop 7
    v_mov_b32 v121, v37
    s_branch KF_FIN2
KF_BG2:
    v_and_b32 v153, 3, v0
    v_lshrrev_b32 v154, 5, v0
    v_bfe_u32 v155, v0, 2, 2
    v_lshl_add_u32 v156, v154, 3, v155
    v_and_b32 v157, 1, v148
    v_and_b32 v158, 31, v0
    s_bfe_u32 s56, s2, 0x20001
    s_lshl_b32 s56, s56, 2
    s_lshr_b32 s35, s2, 6
    s_add_u32 s56, s56, s35
    s_and_b32 s57, s2, 1
    s_lshl_b32 s57, s57, 3
    s_add_u32 s57, s57, s34
    v_and_b32 v151, 7, v0
    v_xor_b32 v150, v151, v148
    v_lshrrev_b32 v152, 3, v0
    v_lshlrev_b32 v152, 10, v152
    v_lshl_add_u32 v56, v150, 4, v152
    v_xor_b32 v60, 64, v56
    s_mul_i32 s61, s52, 1536
    s_add_u32 s35, s61, 0
    v_add_u32 v150, s35, v2
    v_bfe_u32 v152, v150, 6, 5
    v_mul_u32_u24 v152, 3072, v152
    v_lshrrev_b32 v150, 11, v150
    v_lshl_add_u32 v152, v150, 10, v152
    v_lshl_add_u32 v57, v153, 4, v152
    s_add_u32 s35, s61, 1024
    v_add_u32 v150, s35, v2
    v_bfe_u32 v152, v150, 6, 5
    v_mul_u32_u24 v152, 3072, v152
    v_lshrrev_b32 v150, 11, v150
    v_lshl_add_u32 v152, v150, 10, v152
    v_lshl_add_u32 v58, v153, 4, v152
    s_lshl_b32 s53, s56, 17
    s_lshl_b32 s35, s52, 15
    s_add_u32 s53, s53, s35
    s_lshl_b32 s54, s57, 6
    s_lshl_b32 s35, s56, 1
    s_add_u32 s35, s35, s57
    s_and_b32 s35, s35, 7
    s_lshl_b32 s36, s35, 7
    s_add_u32 s53, s53, s36
    s_mul_i32 s36, s35, 196608
    s_add_u32 s54, s54, s36
    s_lshl_b32 s48, s52, 13
    s_add_u32 s48, s48, 102400
    s_lshl_b32 s35, s52, 3
    s_add_u32 s35, s35, 159776
    v_mov_b32 v1, s35
    v_mov_b32 v16, 1
    v_mov_b32 v17, 1
    s_setprio 3
    s_add_u32 m0, s48, 0
    s_add_u32 s35, s53, 0
    buffer_load_dwordx4 v56, s[20:23], s35 offen offset:0 lds
    s_add_u32 s35, s53, 7168
    buffer_load_dwordx4 v60, s[20:23], s35 offen offset:1024 lds
    s_add_u32 m0, s48, 0
    s_add_u32 s35, s53, 14336
    buffer_load_dwordx4 v56, s[20:23], s35 offen offset:2048 lds
    s_add_u32 s35, s53, 21504
    buffer_load_dwordx4 v60, s[20:23], s35 offen offset:3072 lds
    s_add_u32 s53, s53, 128
    s_bitset0_b32 s53, 10
    v_lshlrev_b32 v21, 2, v151
    v_add_u32 v21, 159968, v21
    s_waitcnt vmcnt(5)
    ds_write_b64 v1, v[16:17] offset:160
KF_WKW:
    ds_read_b32 v14, v21
    s_waitcnt lgkmcnt(0)
    v_cmp_ne_u32 vcc, 1, v14
    s_cbranch_vccz KF_WKR
    s_sleep 1
    s_branch KF_WKW
KF_WKR:
    s_waitcnt vmcnt(5)
    ds_write_b64 v1, v[16:17] offset:160
    s_add_u32 m0, s61, 135168
    s_nop 0
    buffer_load_dwordx4 v57, s[24:27], s54 offen lds
    s_add_u32 m0, s61, 136192
    s_mov_b32 exec_hi, 0
    buffer_load_dwordx4 v58, s[24:27], s54 offen lds
    s_mov_b32 exec_hi, -1
    s_add_u32 s54, s54, 98304
    s_sub_u32 s36, s54, 1572864
    s_cselect_b32 s54, s54, s36
    s_add_u32 m0, s61, 141312
    s_nop 0
    buffer_load_dwordx4 v57, s[24:27], s54 offen lds
    s_add_u32 m0, s61, 142336
    s_mov_b32 exec_hi, 0
    buffer_load_dwordx4 v58, s[24:27], s54 offen lds
    s_mov_b32 exec_hi, -1
    s_add_u32 s54, s54, 98304
    s_sub_u32 s36, s54, 1572864
    s_cselect_b32 s54, s54, s36
    s_add_u32 m0, s48, 4096
    s_add_u32 s35, s53, 0
    buffer_load_dwordx4 v56, s[20:23], s35 offen offset:0 lds
    s_add_u32 s35, s53, 7168
    buffer_load_dwordx4 v60, s[20:23], s35 offen offset:1024 lds
    s_add_u32 m0, s48, 4096
    s_add_u32 s35, s53, 14336
    buffer_load_dwordx4 v56, s[20:23], s35 offen offset:2048 lds
    s_add_u32 s35, s53, 21504
    buffer_load_dwordx4 v60, s[20:23], s35 offen offset:3072 lds
    s_add_u32 s53, s53, 128
    s_bitset0_b32 s53, 10
    s_add_u32 m0, s61, 147456
    s_nop 0
    buffer_load_dwordx4 v57, s[24:27], s54 offen lds
    s_add_u32 m0, s61, 148480
    s_mov_b32 exec_hi, 0
    buffer_load_dwordx4 v58, s[24:27], s54 offen lds
    s_mov_b32 exec_hi, -1
    s_add_u32 s54, s54, 98304
    s_sub_u32 s36, s54, 1572864
    s_cselect_b32 s54, s54, s36
    s_mov_b32 s42, 0x3fb8aa3b
    s_mov_b32 s43, 0x3fb8aa3b
    s_mov_b32 s44, 0x358637bd
    s_mov_b32 s45, 0x358637bd
    s_lshl_b32 s59, s57, 12
    s_add_u32 s59, s59, 8650752
    s_lshl_b32 s60, s57, 8
    s_add_u32 s60, s60, 8716288
    v_bfe_u32 v150, v0, 1, 3
    v_xor_b32 v150, v150, v154
    v_lshlrev_b32 v152, 7, v158
    v_lshl_add_u32 v152, v150, 4, v152
    v_add_u32 v136, s48, v152
    v_xor_b32 v137, 32, v136
    v_xor_b32 v138, 64, v136
    v_xor_b32 v139, 96, v136
    v_lshlrev_b32 v150, 6, v156
    v_lshl_add_u32 v150, v157, 5, v150
    v_lshl_add_u32 v150, v153, 3, v150
    v_add_u32 v62, 135168, v150
    v_lshlrev_b32 v150, 2, v153
    v_add_u32 v11, 159920, v150
    s_lshl_b32 s35, s52, 2
    s_add_u32 s35, s35, 159920
    v_mov_b32 v12, s35
    v_mov_b32 v160, 2147483632
    v_cmp_eq_u32 vcc, 0, v0
    s_nop 1
    v_cndmask_b32 v161, v160, v0, vcc
    s_lshl_b32 s35, s52, 12
    s_add_u32 s35, s35, 135168
    v_add_u32 v144, s35, v2
    s_add_u32 s35, s51, 135168
    v_add_u32 v145, s35, v2
    v_lshlrev_b32 v146, 2, v0
    v_cmp_ge_u32 s[62:63], 16, v158
    v_cmp_le_u32 vcc, 15, v158
    s_cmp_lt_u32 s52, 2
    s_cselect_b64 s[62:63], s[62:63], vcc
    v_cndmask_b32 v146, v160, v146, s[62:63]
    v_min_u32 v18, 16, v158
    v_max_u32 v19, 15, v158
    v_lshl_add_u32 v18, v154, 5, v18
    v_lshl_add_u32 v19, v154, 5, v19
    v_lshlrev_b32 v18, 2, v18
    v_lshlrev_b32 v19, 2, v19
    v_lshrrev_b32 v150, 2, v0
    v_lshlrev_b32 v150, 10, v150
    v_lshl_add_u32 v147, v153, 4, v150
    v_lshl_add_u32 v152, v154, 2, v155
    v_lshlrev_b32 v150, 6, v152
    v_lshl_add_u32 v150, v157, 5, v150
    v_lshl_add_u32 v150, v153, 3, v150
    s_mul_i32 s40, s52, 6144
    s_add_u32 s40, s40, 135168
    v_add_u32 v10, s40, v150
    v_lshlrev_b32 v8, 11, v158
    v_lshl_add_u32 v8, v154, 4, v8
    v_mov_b32 v59, 159904
    v_mov_b32 v15, 128
    v_mov_b32 v3, v161
    s_mov_b32 s64, 0x0000ffff
    s_mov_b32 s65, 0x0000ffff
    s_mov_b32 s66, 0xffff0000
    s_mov_b32 s67, 0xffff0000
    v_mov_b64 v[64:65], s[44:45]
    v_mov_b64 v[66:67], s[44:45]
    v_mov_b64 v[68:69], s[44:45]
    v_mov_b64 v[70:71], s[44:45]
    v_mov_b64 v[72:73], s[44:45]
    v_mov_b64 v[74:75], s[44:45]
    v_mov_b64 v[76:77], s[44:45]
    v_mov_b64 v[78:79], s[44:45]
    v_mov_b64 v[80:81], s[44:45]
    v_mov_b64 v[82:83], s[44:45]
    v_mov_b64 v[84:85], s[44:45]
    v_mov_b64 v[86:87], s[44:45]
    v_mov_b64 v[88:89], s[44:45]
    v_mov_b64 v[90:91], s[44:45]
    v_mov_b64 v[92:93], s[44:45]
    v_mov_b64 v[94:95], s[44:45]
    v_mov_b64 v[96:97], 0
    v_mov_b64 v[98:99], 0
    v_mov_b64 v[100:101], 0
    v_mov_b64 v[102:103], 0
    v_mov_b64 v[104:105], 0
    v_mov_b64 v[106:107], 0
    v_mov_b64 v[108:109], 0
    v_mov_b64 v[110:111], 0
    v_mov_b32 v140, 0x3f803f80
    v_mov_b32 v141, 0x3f803f80
    v_mov_b32 v142, 0x3f803f80
    v_mov_b32 v143, 0x3f803f80
    s_waitcnt vmcnt(8)
    v_add_u32 v13, 1, v13
    ds_write_b32 v12, v13
KF_SB1:
    ds_read_b32 v14, v11
    s_waitcnt lgkmcnt(0)
    v_cmp_gt_u32 vcc, v13, v14
    s_cbranch_vccnz KF_SB1
    ds_read_b128 v[112:115], v136 offset:0
    ds_read_b128 v[116:119], v137 offset:0
    ds_read_b128 v[120:123], v138 offset:0
    ds_read_b128 v[124:127], v139 offset:0
    ds_read_b64_tr_b16 v[32:33], v62 offset:2048
    ds_read_b64_tr_b16 v[34:35], v62 offset:2304
    ds_read_b64_tr_b16 v[36:37], v62 offset:4096
    ds_read_b64_tr_b16 v[38:39], v62 offset:4352
    ds_read_b64_tr_b16 v[40:41], v62 offset:0
    ds_read_b64_tr_b16 v[42:43], v62 offset:256
    s_mov_b32 s39, 0
KF_BGLOOP:
    s_waitcnt lgkmcnt(4)
    v_mfma_f32_32x32x16_bf16 v[80:95], v[112:115], v[32:35], v[80:95]
    ds_read_b64_tr_b16 v[44:45], v62 offset:3072
    ds_read_b64_tr_b16 v[46:47], v62 offset:3328
    s_waitcnt vmcnt(4)
    v_add_u32 v13, 1, v13
    ds_write_b32 v12, v13
    s_add_u32 m0, s48, 0
    s_add_u32 s35, s53, 0
    buffer_load_dwordx4 v56, s[20:23], s35 offen offset:0 lds
    s_waitcnt lgkmcnt(5)
    v_mfma_f32_32x32x16_bf16 v[96:111], v[112:115], v[36:39], v[96:111]
    ds_read_b64_tr_b16 v[48:49], v62 offset:5120
    ds_read_b64_tr_b16 v[50:51], v62 offset:5376
    ds_read_b32 v14, v11
    s_add_u32 s35, s53, 7168
    buffer_load_dwordx4 v60, s[20:23], s35 offen offset:1024 lds
    s_waitcnt lgkmcnt(6)
    v_mfma_f32_32x32x16_bf16 v[64:79], v[40:43], v[112:115], v[64:79]
    ds_read_b64_tr_b16 v[52:53], v62 offset:1024
    ds_read_b64_tr_b16 v[54:55], v62 offset:1280
    s_waitcnt lgkmcnt(2)
    v_cmp_gt_u32 vcc, v13, v14
    s_cbranch_vccz KF_SK2
KF_SB3:
    ds_read_b32 v14, v11
    s_waitcnt lgkmcnt(0)
    v_cmp_gt_u32 vcc, v13, v14
    s_cbranch_vccnz KF_SB3
KF_SK2:
    v_mfma_f32_32x32x16_bf16 v[80:95], v[116:119], v[44:47], v[80:95]
    ds_read_b64_tr_b16 v[32:33], v62 offset:8192
    ds_read_b64_tr_b16 v[34:35], v62 offset:8448
    s_add_u32 m0, s61, 153600
    s_nop 0
    buffer_load_dwordx4 v57, s[24:27], s54 offen lds
    v_mfma_f32_32x32x16_bf16 v[96:111], v[116:119], v[48:51], v[96:111]
    ds_read_b64_tr_b16 v[36:37], v62 offset:10240
    ds_read_b64_tr_b16 v[38:39], v62 offset:10496
    s_add_u32 m0, s61, 154624
    s_mov_b32 exec_hi, 0
    buffer_load_dwordx4 v58, s[24:27], s54 offen lds
    s_mov_b32 exec_hi, -1
    s_add_u32 s54, s54, 98304
    s_sub_u32 s36, s54, 1572864
    s_cselect_b32 s54, s54, s36
    s_waitcnt lgkmcnt(4)
    v_mfma_f32_32x32x16_bf16 v[64:79], v[52:55], v[116:119], v[64:79]
    ds_read_b64_tr_b16 v[40:41], v62 offset:6144
    ds_read_b64_tr_b16 v[42:43], v62 offset:6400
    s_cmp_lt_u32 s39, 3
    s_cselect_b32 s26, s26, 0
    s_waitcnt lgkmcnt(4)
    v_mfma_f32_32x32x16_bf16 v[80:95], v[120:123], v[32:35], v[80:95]
    ds_read_b64_tr_b16 v[44:45], v62 offset:9216
    ds_read_b64_tr_b16 v[46:47], v62 offset:9472
    s_waitcnt vmcnt(4)
    v_add_u32 v13, 1, v13
    ds_write_b32 v12, v13
    s_add_u32 m0, s48, 0
    s_add_u32 s35, s53, 14336
    buffer_load_dwordx4 v56, s[20:23], s35 offen offset:2048 lds
    s_waitcnt lgkmcnt(5)
    v_mfma_f32_32x32x16_bf16 v[96:111], v[120:123], v[36:39], v[96:111]
    ds_read_b64_tr_b16 v[48:49], v62 offset:11264
    ds_read_b64_tr_b16 v[50:51], v62 offset:11520
    ds_read_b32 v14, v11
    s_add_u32 s35, s53, 21504
    buffer_load_dwordx4 v60, s[20:23], s35 offen offset:3072 lds
    s_add_u32 s53, s53, 128
    s_bitset0_b32 s53, 10
    s_waitcnt lgkmcnt(6)
    v_mfma_f32_32x32x16_bf16 v[64:79], v[40:43], v[120:123], v[64:79]
    ds_read_b64_tr_b16 v[52:53], v62 offset:7168
    ds_read_b64_tr_b16 v[54:55], v62 offset:7424
    s_waitcnt lgkmcnt(2)
    v_cmp_gt_u32 vcc, v13, v14
    s_cbranch_vccz KF_SK4
KF_SB5:
    ds_read_b32 v14, v11
    s_waitcnt lgkmcnt(0)
    v_cmp_gt_u32 vcc, v13, v14
    s_cbranch_vccnz KF_SB5
KF_SK4:
    v_mfma_f32_32x32x16_bf16 v[80:95], v[124:127], v[44:47], v[80:95]
    ds_read_b128 v[24:27], v136 offset:4096
    ds_read_b128 v[28:31], v137 offset:4096
    ds_read_b128 v[128:131], v138 offset:4096
    ds_read_b128 v[132:135], v139 offset:4096
    ds_read_b64_tr_b16 v[32:33], v62 offset:14336
    ds_read_b64_tr_b16 v[34:35], v62 offset:14592
    s_add_u32 m0, s61, 135168
    s_nop 0
    buffer_load_dwordx4 v57, s[24:27], s54 offen lds
    v_mfma_f32_32x32x16_bf16 v[96:111], v[124:127], v[48:51], v[96:111]
    ds_read_b64_tr_b16 v[36:37], v62 offset:16384
    ds_read_b64_tr_b16 v[38:39], v62 offset:16640
    s_add_u32 m0, s61, 136192
    s_mov_b32 exec_hi, 0
    buffer_load_dwordx4 v58, s[24:27], s54 offen lds
    s_mov_b32 exec_hi, -1
    s_add_u32 s54, s54, 98304
    s_sub_u32 s36, s54, 1572864
    s_cselect_b32 s54, s54, s36
    s_waitcnt lgkmcnt(8)
    v_mfma_f32_32x32x16_bf16 v[64:79], v[52:55], v[124:127], v[64:79]
    ds_read_b64_tr_b16 v[40:41], v62 offset:12288
    ds_read_b64_tr_b16 v[42:43], v62 offset:12544
    s_waitcnt lgkmcnt(4)
    v_mfma_f32_32x32x16_bf16 v[80:95], v[24:27], v[32:35], v[80:95]
    ds_read_b64_tr_b16 v[44:45], v62 offset:15360
    ds_read_b64_tr_b16 v[46:47], v62 offset:15616
    s_waitcnt vmcnt(4)
    v_add_u32 v13, 1, v13
    ds_write_b32 v12, v13
    s_add_u32 m0, s48, 4096
    s_add_u32 s35, s53, 0
    buffer_load_dwordx4 v56, s[20:23], s35 offen offset:0 lds
    s_waitcnt lgkmcnt(5)
    v_mfma_f32_32x32x16_bf16 v[96:111], v[24:27], v[36:39], v[96:111]
    ds_read_b64_tr_b16 v[48:49], v62 offset:17408
    ds_read_b64_tr_b16 v[50:51], v62 offset:17664
    ds_read_b32 v14, v11
    s_add_u32 s35, s53, 7168
    buffer_load_dwordx4 v60, s[20:23], s35 offen offset:1024 lds
    s_waitcnt lgkmcnt(6)
    v_mfma_f32_32x32x16_bf16 v[64:79], v[40:43], v[24:27], v[64:79]
    ds_read_b64_tr_b16 v[52:53], v62 offset:13312
    ds_read_b64_tr_b16 v[54:55], v62 offset:13568
    s_waitcnt lgkmcnt(2)
    v_cmp_gt_u32 vcc, v13, v14
    s_cbranch_vccz KF_SK6
KF_SB7:
    ds_read_b32 v14, v11
    s_waitcnt lgkmcnt(0)
    v_cmp_gt_u32 vcc, v13, v14
    s_cbranch_vccnz KF_SB7
KF_SK6:
    v_mfma_f32_32x32x16_bf16 v[80:95], v[28:31], v[44:47], v[80:95]
    ds_read_b64_tr_b16 v[32:33], v62 offset:20480
    ds_read_b64_tr_b16 v[34:35], v62 offset:20736
    s_add_u32 m0, s61, 141312
    s_nop 0
    buffer_load_dwordx4 v57, s[24:27], s54 offen lds
    v_mfma_f32_32x32x16_bf16 v[96:111], v[28:31], v[48:51], v[96:111]
    ds_read_b64_tr_b16 v[36:37], v62 offset:22528
    ds_read_b64_tr_b16 v[38:39], v62 offset:22784
    s_add_u32 m0, s61, 142336
    s_mov_b32 exec_hi, 0
    buffer_load_dwordx4 v58, s[24:27], s54 offen lds
    s_mov_b32 exec_hi, -1
    s_add_u32 s54, s54, 98304
    s_sub_u32 s36, s54, 1572864
    s_cselect_b32 s54, s54, s36
    s_waitcnt lgkmcnt(4)
    v_mfma_f32_32x32x16_bf16 v[64:79], v[52:55], v[28:31], v[64:79]
    ds_read_b64_tr_b16 v[40:41], v62 offset:18432
    ds_read_b64_tr_b16 v[42:43], v62 offset:18688
    s_waitcnt lgkmcnt(4)
    v_mfma_f32_32x32x16_bf16 v[80:95], v[128:131], v[32:35], v[80:95]
    ds_read_b64_tr_b16 v[44:45], v62 offset:21504
    ds_read_b64_tr_b16 v[46:47], v62 offset:21760
    s_waitcnt vmcnt(4)
    v_add_u32 v13, 1, v13
    ds_write_b32 v12, v13
    s_add_u32 m0, s48, 4096
    s_add_u32 s35, s53, 14336
    buffer_load_dwordx4 v56, s[20:23], s35 offen offset:2048 lds
    s_waitcnt lgkmcnt(5)
    v_mfma_f32_32x32x16_bf16 v[96:111], v[128:131], v[36:39], v[96:111]
    ds_read_b64_tr_b16 v[48:49], v62 offset:23552
    ds_read_b64_tr_b16 v[50:51], v62 offset:23808
    ds_read_b32 v14, v11
    s_add_u32 s35, s53, 21504
    buffer_load_dwordx4 v60, s[20:23], s35 offen offset:3072 lds
    s_add_u32 s53, s53, 128
    s_bitset0_b32 s53, 10
    s_waitcnt lgkmcnt(6)
    v_mfma_f32_32x32x16_bf16 v[64:79], v[40:43], v[128:131], v[64:79]
    ds_read_b64_tr_b16 v[52:53], v62 offset:19456
    ds_read_b64_tr_b16 v[54:55], v62 offset:19712
    s_waitcnt lgkmcnt(2)
    v_cmp_gt_u32 vcc, v13, v14
    s_cbranch_vccz KF_SK8
KF_SB9:
    ds_read_b32 v14, v11
    s_waitcnt lgkmcnt(0)
    v_cmp_gt_u32 vcc, v13, v14
    s_cbranch_vccnz KF_SB9
KF_SK8:
    v_mfma_f32_32x32x16_bf16 v[80:95], v[132:135], v[44:47], v[80:95]
    ds_read_b128 v[112:115], v136 offset:0
    ds_read_b128 v[116:119], v137 offset:0
    ds_read_b128 v[120:123], v138 offset:0
    ds_read_b128 v[124:127], v139 offset:0
    ds_read_b64_tr_b16 v[32:33], v62 offset:2048
    ds_read_b64_tr_b16 v[34:35], v62 offset:2304
    s_add_u32 m0, s61, 147456
    s_nop 0
    buffer_load_dwordx4 v57, s[24:27], s54 offen lds
    v_mfma_f32_32x32x16_bf16 v[96:111], v[132:135], v[48:51], v[96:111]
    ds_read_b64_tr_b16 v[36:37], v62 offset:4096
    ds_read_b64_tr_b16 v[38:39], v62 offset:4352
    s_add_u32 m0, s61, 148480
    s_mov_b32 exec_hi, 0
    buffer_load_dwordx4 v58, s[24:27], s54 offen lds
    s_mov_b32 exec_hi, -1
    s_add_u32 s54, s54, 98304
    s_sub_u32 s36, s54, 1572864
    s_cselect_b32 s54, s54, s36
    s_waitcnt lgkmcnt(8)
    v_mfma_f32_32x32x16_bf16 v[64:79], v[52:55], v[132:135], v[64:79]
    ds_read_b64_tr_b16 v[40:41], v62 offset:0
    ds_read_b64_tr_b16 v[42:43], v62 offset:256
    s_setprio 3
    s_cmp_lt_u32 s39, 2
    s_cselect_b32 s22, s22, 0
    s_add_u32 s39, s39, 1
    s_cmp_lt_u32 s39, 4
    s_cbranch_scc1 KF_BGLOOP
    s_waitcnt vmcnt(0) lgkmcnt(0)
    v_add_u32 v13, 1, v13
    ds_write_b32 v12, v13
    v_cvt_pk_bf16_f32 v128, v96, v97
    v_cvt_pk_bf16_f32 v129, v98, v99
    v_cvt_pk_bf16_f32 v130, v100, v101
    v_cvt_pk_bf16_f32 v131, v102, v103
    v_cvt_pk_bf16_f32 v132, v104, v105
    v_cvt_pk_bf16_f32 v133, v106, v107
    v_cvt_pk_bf16_f32 v134, v108, v109
    v_cvt_pk_bf16_f32 v135, v110, v111
    v_pk_mul_f32 v[112:113], v[80:81], s[42:43]
    v_pk_mul_f32 v[114:115], v[82:83], s[42:43]
    v_pk_mul_f32 v[116:117], v[84:85], s[42:43]
    v_pk_mul_f32 v[118:119], v[86:87], s[42:43]
    v_pk_mul_f32 v[120:121], v[88:89], s[42:43]
    v_pk_mul_f32 v[122:123], v[90:91], s[42:43]
    v_pk_mul_f32 v[124:125], v[92:93], s[42:43]
    v_pk_mul_f32 v[126:127], v[94:95], s[42:43]
    v_exp_f32 v112, v112 clamp
    v_max_f32 v80, s44, v80
    v_exp_f32 v113, v113 clamp
    v_max_f32 v81, s44, v81
    v_exp_f32 v114, v114 clamp
    v_max_f32 v82, s44, v82
    v_exp_f32 v115, v115 clamp
    v_max_f32 v83, s44, v83
    v_exp_f32 v116, v116 clamp
    v_max_f32 v84, s44, v84
    v_exp_f32 v117, v117 clamp
    v_max_f32 v85, s44, v85
    v_exp_f32 v118, v118 clamp
    v_max_f32 v86, s44, v86
    v_exp_f32 v119, v119 clamp
    v_max_f32 v87, s44, v87
    v_exp_f32 v120, v120 clamp
    v_max_f32 v88, s44, v88
    v_exp_f32 v121, v121 clamp
    v_max_f32 v89, s44, v89
    v_exp_f32 v122, v122 clamp
    v_max_f32 v90, s44, v90
    v_exp_f32 v123, v123 clamp
    v_max_f32 v91, s44, v91
    v_exp_f32 v124, v124 clamp
    v_max_f32 v92, s44, v92
    v_exp_f32 v125, v125 clamp
    v_max_f32 v93, s44, v93
    v_exp_f32 v126, v126 clamp
    v_max_f32 v94, s44, v94
    v_exp_f32 v127, v127 clamp
    v_max_f32 v95, s44, v95
    v_pk_add_f32 v[80:81], v[80:81], v[112:113]
    v_pk_add_f32 v[82:83], v[82:83], v[114:115]
    v_pk_add_f32 v[84:85], v[84:85], v[116:117]
    v_pk_add_f32 v[86:87], v[86:87], v[118:119]
    v_pk_add_f32 v[88:89], v[88:89], v[120:121]
    v_pk_add_f32 v[90:91], v[90:91], v[122:123]
    v_pk_add_f32 v[92:93], v[92:93], v[124:125]
    v_pk_add_f32 v[94:95], v[94:95], v[126:127]
    v_cvt_pk_bf16_f32 v112, v80, v81
    v_cvt_pk_bf16_f32 v113, v82, v83
    v_cvt_pk_bf16_f32 v114, v84, v85
    v_cvt_pk_bf16_f32 v115, v86, v87
    v_cvt_pk_bf16_f32 v116, v88, v89
    v_cvt_pk_bf16_f32 v117, v90, v91
    v_cvt_pk_bf16_f32 v118, v92, v93
    v_cvt_pk_bf16_f32 v119, v94, v95
    v_mfma_f32_32x32x16_bf16 v[24:39], v[112:115], v[128:131], 0
    v_mfma_f32_32x32x16_bf16 v[40:55], v[112:115], v[140:143], 0
    v_mfma_f32_32x32x16_bf16 v[24:39], v[116:119], v[132:135], v[24:39]
    v_mfma_f32_32x32x16_bf16 v[40:55], v[116:119], v[140:143], v[40:55]
KF_BKW:
    ds_read_b32 v14, v59
    s_waitcnt lgkmcnt(0)
    v_cmp_ne_u32 vcc, 1, v14
    s_nop 1
    s_cbranch_vccz KF_BKR
    s_sleep 1
    s_branch KF_BKW
KF_BKR:
KF_SB10:
    ds_read_b32 v14, v11
    s_waitcnt lgkmcnt(0)
    v_cmp_gt_u32 vcc, v13, v14
    s_cbranch_vccnz KF_SB10
    s_mov_b64 exec, s[64:65]
    ds_write_b128 v144, v[24:27] offset:0
    ds_write_b128 v144, v[28:31] offset:1024
    ds_write_b128 v144, v[48:51] offset:2048
    ds_write_b128 v144, v[52:55] offset:3072
    s_mov_b64 exec, s[66:67]
    ds_write_b128 v144, v[40:43] offset:0
    ds_write_b128 v144, v[44:47] offset:1024
    ds_write_b128 v144, v[32:35] offset:2048
    ds_write_b128 v144, v[36:39] offset:3072
    s_mov_b64 exec, -1
    s_waitcnt lgkmcnt(0)
    v_add_u32 v13, 1, v13
    ds_write_b32 v12, v13
KF_SB11:
    ds_read_b32 v14, v11
    s_waitcnt lgkmcnt(0)
    v_cmp_gt_u32 vcc, v13, v14
    s_cbranch_vccnz KF_SB11
    ds_read_b128 v[40:43], v145 offset:0
    ds_read_b128 v[44:47], v145 offset:4096
    ds_read_b128 v[48:51], v145 offset:8192
    ds_read_b128 v[52:55], v145 offset:12288
    s_add_u32 s35, s59, s51
    s_waitcnt lgkmcnt(0)
    v_add_u32 v13, 1, v13
    ds_write_b32 v12, v13
    v_pk_add_f32 v[40:41], v[40:41], v[44:45]
    v_pk_add_f32 v[48:49], v[48:49], v[52:53]
    v_pk_add_f32 v[42:43], v[42:43], v[46:47]
    v_pk_add_f32 v[50:51], v[50:51], v[54:55]
    v_pk_add_f32 v[40:41], v[40:41], v[48:49]
    v_pk_add_f32 v[42:43], v[42:43], v[50:51]
    buffer_atomic_add_f32 v40, v146, s[4:7], s35 offen offset:0
    buffer_atomic_add_f32 v41, v146, s[4:7], s35 offen offset:256
    buffer_atomic_add_f32 v42, v146, s[4:7], s35 offen offset:512
    buffer_atomic_add_f32 v43, v146, s[4:7], s35 offen offset:768
    s_add_u32 m0, s51, 102400
    s_nop 0
    buffer_load_dwordx4 v2, s[4:7], m0 offen sc1 lds
    s_add_u32 m0, s51, 106496
    s_nop 0
    buffer_load_dwordx4 v2, s[4:7], m0 offen sc1 lds
    s_add_u32 m0, s51, 110592
    s_nop 0
    buffer_load_dwordx4 v2, s[4:7], m0 offen sc1 lds
    s_add_u32 m0, s51, 114688
    s_nop 0
    buffer_load_dwordx4 v2, s[4:7], m0 offen sc1 lds
    s_add_u32 m0, s51, 118784
    s_nop 0
    buffer_load_dwordx4 v2, s[4:7], m0 offen sc1 lds
    s_add_u32 m0, s51, 122880
    s_nop 0
    buffer_load_dwordx4 v2, s[4:7], m0 offen sc1 lds
    s_add_u32 m0, s51, 126976
    s_nop 0
    buffer_load_dwordx4 v2, s[4:7], m0 offen sc1 lds
    s_add_u32 m0, s51, 131072
    s_nop 0
    buffer_load_dwordx4 v2, s[4:7], m0 offen sc1 lds
    s_waitcnt vmcnt(8)
    v_mov_b32 v22, 1
    buffer_atomic_add v22, v3, s[4:7], s60 offen sc0
    s_lshr_b32 s35, s2, 3
    s_lshl_b32 s35, s35, 2
    s_add_u32 s35, s35, s52
    s_lshl_b32 s35, s35, 12
    s_mov_b32 exec_hi, 0
    buffer_load_dword v20, v7, s[76:79], s35 offen
    s_mov_b32 exec_hi, -1
    v_pk_mul_f32 v[112:113], v[64:65], s[42:43]
    v_pk_mul_f32 v[114:115], v[66:67], s[42:43]
    v_pk_mul_f32 v[116:117], v[68:69], s[42:43]
    v_pk_mul_f32 v[118:119], v[70:71], s[42:43]
    v_pk_mul_f32 v[120:121], v[72:73], s[42:43]
    v_pk_mul_f32 v[122:123], v[74:75], s[42:43]
    v_pk_mul_f32 v[124:125], v[76:77], s[42:43]
    v_pk_mul_f32 v[126:127], v[78:79], s[42:43]
    v_exp_f32 v112, v112 clamp
    v_max_f32 v64, s44, v64
    v_exp_f32 v113, v113 clamp
    v_max_f32 v65, s44, v65
    v_exp_f32 v114, v114 clamp
    v_max_f32 v66, s44, v66
    v_exp_f32 v115, v115 clamp
    v_max_f32 v67, s44, v67
    v_exp_f32 v116, v116 clamp
    v_max_f32 v68, s44, v68
    v_exp_f32 v117, v117 clamp
    v_max_f32 v69, s44, v69
    v_exp_f32 v118, v118 clamp
    v_max_f32 v70, s44, v70
    v_exp_f32 v119, v119 clamp
    v_max_f32 v71, s44, v71
    v_exp_f32 v120, v120 clamp
    v_max_f32 v72, s44, v72
    v_exp_f32 v121, v121 clamp
    v_max_f32 v73, s44, v73
    v_exp_f32 v122, v122 clamp
    v_max_f32 v74, s44, v74
    v_exp_f32 v123, v123 clamp
    v_max_f32 v75, s44, v75
    v_exp_f32 v124, v124 clamp
    v_max_f32 v76, s44, v76
    v_exp_f32 v125, v125 clamp
    v_max_f32 v77, s44, v77
    v_exp_f32 v126, v126 clamp
    v_max_f32 v78, s44, v78
    v_exp_f32 v127, v127 clamp
    v_max_f32 v79, s44, v79
    v_pk_add_f32 v[64:65], v[64:65], v[112:113]
    v_pk_add_f32 v[66:67], v[66:67], v[114:115]
    v_pk_add_f32 v[68:69], v[68:69], v[116:117]
    v_pk_add_f32 v[70:71], v[70:71], v[118:119]
    v_pk_add_f32 v[72:73], v[72:73], v[120:121]
    v_pk_add_f32 v[74:75], v[74:75], v[122:123]
    v_pk_add_f32 v[76:77], v[76:77], v[124:125]
    v_pk_add_f32 v[78:79], v[78:79], v[126:127]
    v_cvt_pk_bf16_f32 v24, v64, v65
    v_cvt_pk_bf16_f32 v25, v66, v67
    v_cvt_pk_bf16_f32 v26, v68, v69
    v_cvt_pk_bf16_f32 v27, v70, v71
    v_cvt_pk_bf16_f32 v28, v72, v73
    v_cvt_pk_bf16_f32 v29, v74, v75
    v_cvt_pk_bf16_f32 v30, v76, v77
    v_cvt_pk_bf16_f32 v31, v78, v79
    s_waitcnt vmcnt(1)
    ds_write_b64 v1, v[16:17] offset:64
    v_readfirstlane_b32 s62, v22
    s_nop 0
    s_cmp_lg_u32 s62, 63
    s_cbranch_scc1 KF_BN1
    buffer_store_dword v16, v3, s[4:7], s60 offen offset:128 sc1
KF_BN1:
KF_SB12:
    ds_read_b32 v14, v11
    s_waitcnt lgkmcnt(0)
    v_cmp_gt_u32 vcc, v13, v14
    s_cbranch_vccnz KF_SB12
    s_lshr_b32 s36, s52, 1
    s_lshl_b32 s54, s36, 18
    s_lshl_b32 s35, s34, 7
    s_add_u32 s54, s54, s35
    s_and_b32 s37, s52, 1
    s_lshl_b32 s35, s37, 6
    s_add_u32 s54, s54, s35
    s_add_u32 m0, s40, 0
    s_add_u32 s35, s54, 0
    buffer_load_dwordx4 v147, s[72:75], s35 offen lds
    s_add_u32 m0, s40, 1024
    s_add_u32 s35, s54, 16384
    buffer_load_dwordx4 v147, s[72:75], s35 offen lds
    s_add_u32 m0, s40, 2048
    s_add_u32 s35, s54, 32768
    buffer_load_dwordx4 v147, s[72:75], s35 offen lds
    s_add_u32 m0, s40, 3072
    s_add_u32 s35, s54, 49152
    buffer_load_dwordx4 v147, s[72:75], s35 offen lds
    s_add_u32 m0, s40, 4096
    s_add_u32 s35, s54, 65536
    buffer_load_dwordx4 v147, s[72:75], s35 offen lds
    s_add_u32 m0, s40, 5120
    s_add_u32 s35, s54, 81920
    buffer_load_dwordx4 v147, s[72:75], s35 offen lds
    s_waitcnt vmcnt(4)
    ds_read_b64_tr_b16 v[80:81], v10 offset:0
    ds_read_b64_tr_b16 v[82:83], v10 offset:512
    ds_read_b64_tr_b16 v[84:85], v10 offset:1024
    ds_read_b64_tr_b16 v[86:87], v10 offset:1536
    s_waitcnt lgkmcnt(0)
    s_add_u32 m0, s40, 0
    s_add_u32 s35, s54, 98304
    buffer_load_dwordx4 v147, s[72:75], s35 offen lds
    s_add_u32 m0, s40, 1024
    s_add_u32 s35, s54, 114688
    buffer_load_dwordx4 v147, s[72:75], s35 offen lds
    s_waitcnt vmcnt(4)
    ds_read_b64_tr_b16 v[88:89], v10 offset:2048
    ds_read_b64_tr_b16 v[90:91], v10 offset:2560
    ds_read_b64_tr_b16 v[92:93], v10 offset:3072
    ds_read_b64_tr_b16 v[94:95], v10 offset:3584
    s_waitcnt lgkmcnt(0)
    s_add_u32 m0, s40, 2048
    s_add_u32 s35, s54, 131072
    buffer_load_dwordx4 v147, s[72:75], s35 offen lds
    s_add_u32 m0, s40, 3072
    s_add_u32 s35, s54, 147456
    buffer_load_dwordx4 v147, s[72:75], s35 offen lds
    s_waitcnt vmcnt(4)
    ds_read_b64_tr_b16 v[96:97], v10 offset:4096
    ds_read_b64_tr_b16 v[98:99], v10 offset:4608
    ds_read_b64_tr_b16 v[100:101], v10 offset:5120
    ds_read_b64_tr_b16 v[102:103], v10 offset:5632
    s_waitcnt lgkmcnt(0)
    s_add_u32 m0, s40, 4096
    s_add_u32 s35, s54, 163840
    buffer_load_dwordx4 v147, s[72:75], s35 offen lds
    s_add_u32 m0, s40, 5120
    s_add_u32 s35, s54, 180224
    buffer_load_dwordx4 v147, s[72:75], s35 offen lds
    s_waitcnt vmcnt(4)
    ds_read_b64_tr_b16 v[104:105], v10 offset:0
    ds_read_b64_tr_b16 v[106:107], v10 offset:512
    ds_read_b64_tr_b16 v[108:109], v10 offset:1024
    ds_read_b64_tr_b16 v[110:111], v10 offset:1536
    s_waitcnt lgkmcnt(0)
    s_add_u32 m0, s40, 0
    s_add_u32 s35, s54, 196608
    buffer_load_dwordx4 v147, s[72:75], s35 offen lds
    s_add_u32 m0, s40, 1024
    s_add_u32 s35, s54, 212992
    buffer_load_dwordx4 v147, s[72:75], s35 offen lds
    s_waitcnt vmcnt(4)
    ds_read_b64_tr_b16 v[112:113], v10 offset:2048
    ds_read_b64_tr_b16 v[114:115], v10 offset:2560
    ds_read_b64_tr_b16 v[116:117], v10 offset:3072
    ds_read_b64_tr_b16 v[118:119], v10 offset:3584
    s_waitcnt lgkmcnt(0)
    s_add_u32 m0, s40, 2048
    s_add_u32 s35, s54, 229376
    buffer_load_dwordx4 v147, s[72:75], s35 offen lds
    s_add_u32 m0, s40, 3072
    s_add_u32 s35, s54, 245760
    buffer_load_dwordx4 v147, s[72:75], s35 offen lds
    s_waitcnt vmcnt(4)
    ds_read_b64_tr_b16 v[120:121], v10 offset:4096
    ds_read_b64_tr_b16 v[122:123], v10 offset:4608
    ds_read_b64_tr_b16 v[124:125], v10 offset:5120
    ds_read_b64_tr_b16 v[126:127], v10 offset:5632
    s_waitcnt vmcnt(2)
    ds_read_b64_tr_b16 v[128:129], v10 offset:0
    ds_read_b64_tr_b16 v[130:131], v10 offset:512
    ds_read_b64_tr_b16 v[132:133], v10 offset:1024
    ds_read_b64_tr_b16 v[134:135], v10 offset:1536
    s_waitcnt vmcnt(0)
    ds_read_b64_tr_b16 v[136:137], v10 offset:2048
    ds_read_b64_tr_b16 v[138:139], v10 offset:2560
    ds_read_b64_tr_b16 v[140:141], v10 offset:3072
    ds_read_b64_tr_b16 v[142:143], v10 offset:3584
    s_cmp_lg_u32 s52, 0
    s_cbranch_scc1 KF_BP1
    s_mov_b32 s39, 0
KF_BGPOLL:
    buffer_load_dword v14, v15, s[4:7], s60 offen sc1
    s_add_u32 s39, s39, 1
    s_waitcnt vmcnt(0)
    v_cmp_gt_u32 vcc, 1, v14
    s_cbranch_vccz KF_BGPOLL_OK
    s_sleep 2
    s_cmp_lt_u32 s39, 0x20000
    s_cbranch_scc1 KF_BGPOLL
KF_BGPOLL_OK:
KF_BP1:
    v_add_u32 v13, 1, v13
    ds_write_b32 v12, v13
KF_SB13:
    s_sleep 4
    ds_read_b32 v14, v11
    s_waitcnt lgkmcnt(0)
    v_cmp_gt_u32 vcc, v13, v14
    s_cbranch_vccnz KF_SB13
    buffer_load_dword v40, v18, s[4:7], s59 offen offset:0 sc1
    buffer_load_dword v41, v18, s[4:7], s59 offen offset:256 sc1
    buffer_load_dword v42, v18, s[4:7], s59 offen offset:512 sc1
    buffer_load_dword v43, v18, s[4:7], s59 offen offset:768 sc1
    buffer_load_dword v44, v18, s[4:7], s59 offen offset:1024 sc1
    buffer_load_dword v45, v18, s[4:7], s59 offen offset:1280 sc1
    buffer_load_dword v46, v18, s[4:7], s59 offen offset:1536 sc1
    buffer_load_dword v47, v18, s[4:7], s59 offen offset:1792 sc1
    buffer_load_dword v48, v19, s[4:7], s59 offen offset:2048 sc1
    buffer_load_dword v49, v19, s[4:7], s59 offen offset:2304 sc1
    buffer_load_dword v50, v19, s[4:7], s59 offen offset:2560 sc1
    buffer_load_dword v51, v19, s[4:7], s59 offen offset:2816 sc1
    buffer_load_dword v52, v19, s[4:7], s59 offen offset:3072 sc1
    buffer_load_dword v53, v19, s[4:7], s59 offen offset:3328 sc1
    buffer_load_dword v54, v19, s[4:7], s59 offen offset:3584 sc1
    buffer_load_dword v55, v19, s[4:7], s59 offen offset:3840 sc1
    s_lshl_b32 s35, s56, 17
    s_lshl_b32 s48, s52, 15
    s_add_u32 s35, s35, s48
    s_lshl_b32 s48, s57, 11
    s_add_u32 s35, s35, s48
    s_add_u32 s35, s35, 4456448
    s_lshl_b32 s60, s56, 8
    s_add_u32 s60, s60, 8720384
    s_lshl_b32 s53, s33, 16
    s_lshl_b32 s58, s53, 1
    s_lshl_b32 s48, s36, 16
    s_add_u32 s58, s58, s48
    s_and_b32 s48, s54, 0x3ff
    s_add_u32 s58, s58, s48
    s_lshl_b32 s48, s36, 14
    s_add_u32 s53, s53, s48
    s_add_u32 s53, s53, 4456448
    s_lshl_b32 s48, s36, 15
    s_add_u32 s49, s53, s48
    s_xor_b32 s48, s48, 32768
    s_add_u32 s53, s53, s48
    v_mov_b32 v5, v144
    s_xor_b32 s48, s52, 2
    s_lshl_b32 s48, s48, 12
    s_add_u32 s48, s48, 135168
    v_add_u32 v6, s48, v2
    s_waitcnt vmcnt(0)
    v_cvt_pk_bf16_f32 v32, v40, v41
    v_cvt_pk_bf16_f32 v33, v42, v43
    v_cvt_pk_bf16_f32 v34, v44, v45
    v_cvt_pk_bf16_f32 v35, v46, v47
    v_cvt_pk_bf16_f32 v36, v48, v49
    v_cvt_pk_bf16_f32 v37, v50, v51
    v_cvt_pk_bf16_f32 v38, v52, v53
    v_cvt_pk_bf16_f32 v39, v54, v55
    v_mfma_f32_32x32x16_bf16 v[40:55], v[32:35], v[24:27], 0
    s_nop 0
    v_mfma_f32_32x32x16_bf16 v[56:71], v[36:39], v[28:31], 0
    s_nop 9
    v_add_f32 v20, s44, v48
    v_rcp_f32 v20, v20
    s_nop 0
    v_pk_mul_f32 v[40:41], v[40:41], v[20:21] op_sel_hi:[1,0]
    v_pk_mul_f32 v[42:43], v[42:43], v[20:21] op_sel_hi:[1,0]
    v_pk_mul_f32 v[44:45], v[44:45], v[20:21] op_sel_hi:[1,0]
    v_pk_mul_f32 v[46:47], v[46:47], v[20:21] op_sel_hi:[1,0]
    v_cvt_pk_bf16_f32 v72, v40, v41
    v_cvt_pk_bf16_f32 v73, v42, v43
    v_cvt_pk_bf16_f32 v74, v44, v45
    v_cvt_pk_bf16_f32 v75, v46, v47
    buffer_store_dwordx4 v[72:75], v2, s[4:7], s35 offen offset:0 sc1
    v_add_f32 v20, s44, v56
    v_rcp_f32 v20, v20
    s_nop 0
    v_pk_mul_f32 v[64:65], v[64:65], v[20:21] op_sel_hi:[1,0]
    v_pk_mul_f32 v[66:67], v[66:67], v[20:21] op_sel_hi:[1,0]
    v_pk_mul_f32 v[68:69], v[68:69], v[20:21] op_sel_hi:[1,0]
    v_pk_mul_f32 v[70:71], v[70:71], v[20:21] op_sel_hi:[1,0]
    v_cvt_pk_bf16_f32 v76, v64, v65
    v_cvt_pk_bf16_f32 v77, v66, v67
    v_cvt_pk_bf16_f32 v78, v68, v69
    v_cvt_pk_bf16_f32 v79, v70, v71
    buffer_store_dwordx4 v[76:79], v2, s[4:7], s35 offen offset:1024 sc1
    s_waitcnt vmcnt(0)
    v_add_u32 v13, 1, v13
    ds_write_b32 v12, v13
    s_cmp_lg_u32 s52, 0
    s_cbranch_scc1 KF_BP2
KF_SB14:
    ds_read_b32 v14, v11
    s_waitcnt lgkmcnt(0)
    v_cmp_gt_u32 vcc, v13, v14
    s_cbranch_vccnz KF_SB14
    v_mov_b32 v22, 1
    buffer_atomic_add v22, v3, s[4:7], s60 offen sc0
    s_waitcnt vmcnt(0)
    v_readfirstlane_b32 s62, v22
    s_nop 0
    s_cmp_lg_u32 s62, 15
    s_cbranch_scc1 KF_BN2
    buffer_store_dword v16, v3, s[4:7], s60 offen offset:128 sc1
KF_BN2:
    s_lshr_b32 s60, s33, 1
    s_lshl_b32 s60, s60, 8
    s_add_u32 s60, s60, 8720384
    s_mov_b32 s39, 0
KF_BGP2:
    buffer_load_dword v14, v15, s[4:7], s60 offen sc1
    s_add_u32 s39, s39, 1
    s_waitcnt vmcnt(0)
    v_cmp_gt_u32 vcc, 1, v14
    s_cbranch_vccz KF_BGP2_OK
    s_sleep 2
    s_cmp_lt_u32 s39, 0x20000
    s_cbranch_scc1 KF_BGP2
KF_BGP2_OK:
KF_BP2:
    v_add_u32 v13, 1, v13
    ds_write_b32 v12, v13
KF_SB15:
    s_sleep 4
    ds_read_b32 v14, v11
    s_waitcnt lgkmcnt(0)
    v_cmp_gt_u32 vcc, v13, v14
    s_cbranch_vccnz KF_SB15
    buffer_load_dwordx4 v[56:59], v2, s[4:7], s49 offen offset:0 sc1
    buffer_load_dwordx4 v[60:63], v2, s[4:7], s53 offen offset:0 sc1
    buffer_load_dwordx4 v[64:67], v2, s[4:7], s49 offen offset:1024 sc1
    buffer_load_dwordx4 v[68:71], v2, s[4:7], s53 offen offset:1024 sc1
    buffer_load_dwordx4 v[72:75], v2, s[4:7], s49 offen offset:2048 sc1
    buffer_load_dwordx4 v[76:79], v2, s[4:7], s53 offen offset:2048 sc1
    buffer_load_dwordx4 v[144:147], v2, s[4:7], s49 offen offset:3072 sc1
    buffer_load_dwordx4 v[148:151], v2, s[4:7], s53 offen offset:3072 sc1
    s_add_u32 s49, s49, 4096
    buffer_load_dwordx4 v[152:155], v2, s[4:7], s49 offen offset:0 sc1
    s_add_u32 s53, s53, 4096
    buffer_load_dwordx4 v[156:159], v2, s[4:7], s53 offen offset:0 sc1
    buffer_load_dwordx4 v[160:163], v2, s[4:7], s49 offen offset:1024 sc1
    buffer_load_dwordx4 v[164:167], v2, s[4:7], s53 offen offset:1024 sc1
    s_waitcnt vmcnt(11)
    v_mfma_f32_32x32x16_bf16 v[24:39], v[80:83], v[56:59], 0
    buffer_load_dwordx4 v[56:59], v2, s[4:7], s49 offen offset:2048 sc1
    s_waitcnt vmcnt(11)
    v_mfma_f32_32x32x16_bf16 v[40:55], v[80:83], v[60:63], 0
    buffer_load_dwordx4 v[60:63], v2, s[4:7], s53 offen offset:2048 sc1
    buffer_load_dwordx4 v[80:83], v2, s[4:7], s49 offen offset:3072 sc1
    s_waitcnt vmcnt(12)
    v_mfma_f32_32x32x16_bf16 v[24:39], v[84:87], v[64:67], v[24:39]
    buffer_load_dwordx4 v[64:67], v2, s[4:7], s53 offen offset:3072 sc1
    s_waitcnt vmcnt(12)
    v_mfma_f32_32x32x16_bf16 v[40:55], v[84:87], v[68:71], v[40:55]
    s_add_u32 s49, s49, 4096
    buffer_load_dwordx4 v[68:71], v2, s[4:7], s49 offen offset:0 sc1
    s_add_u32 s53, s53, 4096
    buffer_load_dwordx4 v[84:87], v2, s[4:7], s53 offen offset:0 sc1
    s_waitcnt vmcnt(13)
    v_mfma_f32_32x32x16_bf16 v[24:39], v[88:91], v[72:75], v[24:39]
    buffer_load_dwordx4 v[72:75], v2, s[4:7], s49 offen offset:1024 sc1
    s_waitcnt vmcnt(13)
    v_mfma_f32_32x32x16_bf16 v[40:55], v[88:91], v[76:79], v[40:55]
    buffer_load_dwordx4 v[76:79], v2, s[4:7], s53 offen offset:1024 sc1
    buffer_load_dwordx4 v[88:91], v2, s[4:7], s49 offen offset:2048 sc1
    s_waitcnt vmcnt(14)
    v_mfma_f32_32x32x16_bf16 v[24:39], v[92:95], v[144:147], v[24:39]
    buffer_load_dwordx4 v[144:147], v2, s[4:7], s53 offen offset:2048 sc1
    s_waitcnt vmcnt(14)
    v_mfma_f32_32x32x16_bf16 v[40:55], v[92:95], v[148:151], v[40:55]
    buffer_load_dwordx4 v[148:151], v2, s[4:7], s49 offen offset:3072 sc1
    buffer_load_dwordx4 v[92:95], v2, s[4:7], s53 offen offset:3072 sc1
    s_waitcnt vmcnt(15)
    v_mfma_f32_32x32x16_bf16 v[24:39], v[96:99], v[152:155], v[24:39]
    s_add_u32 s49, s49, 4096
    buffer_load_dwordx4 v[152:155], v2, s[4:7], s49 offen offset:0 sc1
    s_waitcnt vmcnt(15)
    v_mfma_f32_32x32x16_bf16 v[40:55], v[96:99], v[156:159], v[40:55]
    s_add_u32 s53, s53, 4096
    buffer_load_dwordx4 v[156:159], v2, s[4:7], s53 offen offset:0 sc1
    buffer_load_dwordx4 v[96:99], v2, s[4:7], s49 offen offset:1024 sc1
    s_waitcnt vmcnt(16)
    v_mfma_f32_32x32x16_bf16 v[24:39], v[100:103], v[160:163], v[24:39]
    buffer_load_dwordx4 v[160:163], v2, s[4:7], s53 offen offset:1024 sc1
    s_waitcnt vmcnt(16)
    v_mfma_f32_32x32x16_bf16 v[40:55], v[100:103], v[164:167], v[40:55]
    buffer_load_dwordx4 v[164:167], v2, s[4:7], s49 offen offset:2048 sc1
    buffer_load_dwordx4 v[100:103], v2, s[4:7], s53 offen offset:2048 sc1
    s_waitcnt vmcnt(17)
    v_mfma_f32_32x32x16_bf16 v[24:39], v[104:107], v[56:59], v[24:39]
    buffer_load_dwordx4 v[56:59], v2, s[4:7], s49 offen offset:3072 sc1
    s_waitcnt vmcnt(17)
    v_mfma_f32_32x32x16_bf16 v[40:55], v[104:107], v[60:63], v[40:55]
    buffer_load_dwordx4 v[60:63], v2, s[4:7], s53 offen offset:3072 sc1
    s_waitcnt vmcnt(17)
    v_mfma_f32_32x32x16_bf16 v[24:39], v[108:111], v[80:83], v[24:39]
    s_waitcnt vmcnt(16)
    v_mfma_f32_32x32x16_bf16 v[40:55], v[108:111], v[64:67], v[40:55]
    s_waitcnt vmcnt(15)
    v_mfma_f32_32x32x16_bf16 v[24:39], v[112:115], v[68:71], v[24:39]
    s_waitcnt vmcnt(14)
    v_mfma_f32_32x32x16_bf16 v[40:55], v[112:115], v[84:87], v[40:55]
    s_waitcnt vmcnt(13)
    v_mfma_f32_32x32x16_bf16 v[24:39], v[116:119], v[72:75], v[24:39]
    s_waitcnt vmcnt(12)
    v_mfma_f32_32x32x16_bf16 v[40:55], v[116:119], v[76:79], v[40:55]
    s_waitcnt vmcnt(11)
    v_mfma_f32_32x32x16_bf16 v[24:39], v[120:123], v[88:91], v[24:39]
    s_waitcnt vmcnt(10)
    v_mfma_f32_32x32x16_bf16 v[40:55], v[120:123], v[144:147], v[40:55]
    s_waitcnt vmcnt(9)
    v_mfma_f32_32x32x16_bf16 v[24:39], v[124:127], v[148:151], v[24:39]
    s_waitcnt vmcnt(8)
    v_mfma_f32_32x32x16_bf16 v[40:55], v[124:127], v[92:95], v[40:55]
    s_waitcnt vmcnt(7)
    v_mfma_f32_32x32x16_bf16 v[24:39], v[128:131], v[152:155], v[24:39]
    s_waitcnt vmcnt(6)
    v_mfma_f32_32x32x16_bf16 v[40:55], v[128:131], v[156:159], v[40:55]
    s_waitcnt vmcnt(5)
    v_mfma_f32_32x32x16_bf16 v[24:39], v[132:135], v[96:99], v[24:39]
    s_waitcnt vmcnt(4)
    v_mfma_f32_32x32x16_bf16 v[40:55], v[132:135], v[160:163], v[40:55]
    s_waitcnt vmcnt(3)
    v_mfma_f32_32x32x16_bf16 v[24:39], v[136:139], v[164:167], v[24:39]
    s_waitcnt vmcnt(2)
    v_mfma_f32_32x32x16_bf16 v[40:55], v[136:139], v[100:103], v[40:55]
    s_waitcnt vmcnt(1)
    v_mfma_f32_32x32x16_bf16 v[24:39], v[140:143], v[56:59], v[24:39]
    s_waitcnt vmcnt(0)
    v_mfma_f32_32x32x16_bf16 v[40:55], v[140:143], v[60:63], v[40:55]
    s_nop 11
    ds_write_b128 v5, v[40:43] offset:0
    ds_write_b128 v5, v[44:47] offset:1024
    ds_write_b128 v5, v[48:51] offset:2048
    ds_write_b128 v5, v[52:55] offset:3072
    s_waitcnt lgkmcnt(0)
    v_add_u32 v13, 1, v13
    ds_write_b32 v12, v13
KF_SB16:
    ds_read_b32 v14, v11
    s_waitcnt lgkmcnt(0)
    v_cmp_gt_u32 vcc, v13, v14
    s_cbranch_vccnz KF_SB16
    ds_read_b128 v[56:59], v6 offset:0
    ds_read_b128 v[60:63], v6 offset:1024
    ds_read_b128 v[64:67], v6 offset:2048
    ds_read_b128 v[68:71], v6 offset:3072
    s_waitcnt lgkmcnt(0)
    ds_write_b64 v1, v[16:17] offset:96
    v_pk_add_f32 v[24:25], v[24:25], v[56:57]
    v_pk_add_f32 v[26:27], v[26:27], v[58:59]
    v_pk_add_f32 v[28:29], v[28:29], v[60:61]
    v_pk_add_f32 v[30:31], v[30:31], v[62:63]
    v_pk_add_f32 v[32:33], v[32:33], v[64:65]
    v_pk_add_f32 v[34:35], v[34:35], v[66:67]
    v_pk_add_f32 v[36:37], v[36:37], v[68:69]
    v_pk_add_f32 v[38:39], v[38:39], v[70:71]
    v_cvt_pk_bf16_f32 v72, v24, v25
    v_cvt_pk_bf16_f32 v73, v26, v27
    v_cvt_pk_bf16_f32 v74, v28, v29
    v_cvt_pk_bf16_f32 v75, v30, v31
    s_nop 0
    v_permlane32_swap_b32 v72, v74
    v_permlane32_swap_b32 v73, v75
    buffer_store_dwordx4 v[72:75], v8, s[68:71], s58 offen offset:0 sc1
    v_cvt_pk_bf16_f32 v76, v32, v33
    v_cvt_pk_bf16_f32 v77, v34, v35
    v_cvt_pk_bf16_f32 v78, v36, v37
    v_cvt_pk_bf16_f32 v79, v38, v39
    s_nop 0
    v_permlane32_swap_b32 v76, v78
    v_permlane32_swap_b32 v77, v79
    buffer_store_dwordx4 v[76:79], v8, s[68:71], s58 offen offset:32 sc1
    s_endpgm
KF_END:
    s_endpgm
.section .rodata,"a"
.p2align 6
.amdhsa_kernel concat_heads__linear_attn_block__grouped_kv_mqa__prompt_kernel
  .amdhsa_next_free_vgpr 168
  .amdhsa_next_free_sgpr 102
  .amdhsa_accum_offset 168
  .amdhsa_group_segment_fixed_size 0
  .amdhsa_kernarg_size 88
  .amdhsa_user_sgpr_count 2
  .amdhsa_user_sgpr_kernarg_segment_ptr 1
  .amdhsa_system_sgpr_workgroup_id_x 1
.end_amdhsa_kernel
```
